```python
import torch

def _softmax(x, axis=-1):
    return torch.softmax(x, dim=axis)
def _gelu(x):
    return torch.nn.functional.gelu(x, approximate="tanh")
def _silu(x):
    return torch.nn.functional.silu(x)
def _sigmoid(x):
    return torch.sigmoid(x)
def _layernorm(x, axis=-1, eps=1e-5):
    m = x.mean(dim=axis, keepdim=True)
    v = x.var(dim=axis, keepdim=True, unbiased=False)
    return (x - m) / torch.sqrt(v + eps)
def _scatter_add(tgt, idx, src, axis=0):
    return tgt.clone().index_add_(axis, idx, src)
def _segment_sum(src, seg, n):
    out = torch.zeros((n,) + src.shape[1:], dtype=src.dtype)
    return out.index_add_(0, seg, src)
def _pad(x, pw):
    flat = tuple(v for pair in reversed(pw) for v in pair)
    return torch.nn.functional.pad(x, flat)

kernel_name = 'interleave_layers__softmax_full_mha__glu_gated_glu__prompt'

def setup_inputs():

    _w = (lambda a: (lambda t: t.to(torch.bfloat16) if t.is_floating_point() else t)(torch.as_tensor(a)))
    def _A_setup():
        B, S, D = 1, 2048, 512
        return {
            "x": _w((lambda *s: torch.randn(*s, dtype=torch.bfloat16) * 0.05)(B, S, D)),
            "wqkv": _w((lambda *s: torch.randn(*s, dtype=torch.bfloat16) * 0.05)(D, 3 * D)),
            "wo": _w((lambda *s: torch.randn(*s, dtype=torch.bfloat16) * 0.05)(D, D)),
        }
    _A_in = _A_setup()

    def _B_setup():
        B, S, D, F = 1, 2048, 512, 1792
        return {
            "x": _w((lambda *s: torch.randn(*s, dtype=torch.bfloat16) * 0.05)(B, S, D)),
            "w_gate": _w((lambda *s: torch.randn(*s, dtype=torch.bfloat16) * 0.05)(D, F)),
            "w_up": _w((lambda *s: torch.randn(*s, dtype=torch.bfloat16) * 0.05)(D, F)),
            "w_down": _w((lambda *s: torch.randn(*s, dtype=torch.bfloat16) * 0.05)(F, D)),
        }
    _B_in = _B_setup()

    return {
        "A_x": _A_in["x"],
        "A_wqkv": _A_in["wqkv"],
        "A_wo": _A_in["wo"],
        "B_x": _B_in["x"],
        "B_w_gate": _B_in["w_gate"],
        "B_w_up": _B_in["w_up"],
        "B_w_down": _B_in["w_down"],
    }

def reference(A_x, A_wqkv, A_wo, B_x, B_w_gate, B_w_up, B_w_down):
    def _A_ref(x, wqkv, wo):
        B, S, D = x.shape
        H = 32; Dh = D // H
        qkv = (lambda x, *d: x.permute(*d))((x @ wqkv).reshape(B, S, 3, H, Dh), 2, 0, 3, 1, 4)
        q, k, v = qkv[0], qkv[1], qkv[2]
        scale = Dh ** -0.5
        scores = torch.einsum("bhqd,bhkd->bhqk", q, k) * scale
        p = _softmax(scores, axis=-1)
        o = torch.einsum("bhqk,bhkd->bhqd", p, v)
        return (lambda x, *d: x.permute(*d))(o, 0, 2, 1, 3).reshape(B, S, D) @ wo

    def _B_ref(x, w_gate, w_up, w_down):
        g = torch.einsum("bsd,df->bsf", x, w_gate)
        u = torch.einsum("bsd,df->bsf", x, w_up)
        h = _sigmoid(g) * u
        return torch.einsum("bsf,fd->bsd", h, w_down)

    x = A_x
    x = x + _A_ref(_layernorm(x, axis=-1), A_wqkv, A_wo)
    x = x + _B_ref(_layernorm(x, axis=-1), B_w_gate, B_w_up, B_w_down)
    x = x + _A_ref(_layernorm(x, axis=-1), A_wqkv, A_wo)
    x = x + _B_ref(_layernorm(x, axis=-1), B_w_gate, B_w_up, B_w_down)
    return x
```

```asm
; @launch grid=(256,1,1) block=(256,1,1) lds=163840
.amdgcn_target "amdgcn-amd-amdhsa--gfx950"
.text
.globl interleave_layers__softmax_full_mha__glu_gated_glu__prompt_kernel
.p2align 8
.type interleave_layers__softmax_full_mha__glu_gated_glu__prompt_kernel,@function
interleave_layers__softmax_full_mha__glu_gated_glu__prompt_kernel:
    s_cmp_ge_u32 s2, 256
    s_cbranch_scc1 mg_END
    s_load_dwordx2 s[4:5], s[0:1], 72
    v_and_b32 v1, 63, v0
    v_lshrrev_b32 v2, 6, v0
    s_nop 0
    v_readfirstlane_b32 s20, v2
    s_mov_b32 s3, 0
    s_mov_b32 s7, 0
    s_mov_b32 s64, 50331648
    s_mov_b32 s6, 0
    s_and_b32 s27, s2, 7
    s_lshr_b32 s28, s2, 3
    s_lshr_b32 s29, s27, 1
    s_and_b32 s30, s27, 1
    s_lshl_b32 s21, s29, 2
    s_and_b32 s31, s28, 3
    s_add_u32 s21, s21, s31
    s_lshl_b32 s22, s30, 3
    s_lshr_b32 s31, s28, 2
    s_add_u32 s22, s22, s31
    s_lshl_b32 s23, s27, 2
    s_and_b32 s31, s28, 3
    s_add_u32 s23, s23, s31
    s_lshr_b32 s24, s28, 2
    s_lshl_b32 s25, s27, 2
    s_lshr_b32 s31, s28, 3
    s_add_u32 s25, s25, s31
    s_and_b32 s26, s28, 7
    v_lshlrev_b32 v3, 4, v1
    v_and_b32 v4, 31, v1
    v_lshrrev_b32 v5, 5, v1
    s_and_b32 s27, s20, 1
    s_lshl_b32 s27, s27, 1
    s_sub_u32 s27, 1, s27
    s_mul_i32 s78, s27, 114688
    s_lshr_b32 s27, s20, 1
    s_lshl_b32 s27, s27, 1
    s_sub_u32 s27, 1, s27
    s_mul_i32 s79, s27, 114688
    s_lshl_b32 s27, s21, 1
    v_lshrrev_b32 v6, 5, v1
    v_add_u32 v6, s27, v6
    v_lshrrev_b32 v7, 2, v6
    v_and_b32 v6, 3, v6
    v_lshl_add_u32 v6, v6, 3, v7
    v_bfe_u32 v7, v1, 1, 3
    v_lshl_add_u32 v6, v7, 5, v6
    v_lshlrev_b32 v6, 7, v6
    v_bfe_u32 v7, v1, 4, 1
    v_lshl_add_u32 v6, v7, 3, v6
    v_and_b32 v7, 1, v1
    v_lshl_add_u32 v250, v7, 2, v6
    s_lshr_b32 s27, s25, 1
    s_lshr_b32 s28, s27, 3
    s_and_b32 s29, s27, 7
    s_lshl_b32 s29, s29, 5
    s_add_u32 s28, s28, s29
    s_lshr_b32 s30, s26, 1
    s_lshl_b32 s30, s30, 1
    s_and_b32 s31, s26, 1
    s_lshl_b32 s31, s31, 4
    s_add_u32 s30, s30, s31
    s_add_u32 s30, s30, s28
    v_and_b32 v6, 3, v1
    v_lshlrev_b32 v6, 1, v6
    v_bfe_u32 v7, v1, 2, 2
    v_lshl_add_u32 v6, v7, 3, v6
    v_add_u32 v6, s28, v6
    v_and_b32 v7, 1, v1
    v_lshl_add_u32 v7, v7, 3, s30
    v_cmp_gt_u32 vcc, 16, v1
    s_nop 1
    v_cndmask_b32 v6, v7, v6, vcc
    v_lshlrev_b32 v251, 7, v6
    s_lshr_b32 s27, s23, 2
    s_lshl_b32 s27, s27, 10
    s_and_b32 s28, s23, 3
    s_lshl_b32 s28, s28, 2
    s_add_u32 s27, s27, s28
    v_bfe_u32 v6, v1, 2, 3
    v_and_b32 v7, 3, v1
    v_lshl_add_u32 v6, v7, 6, v6
    v_lshlrev_b32 v6, 7, v6
    v_add_u32 v252, s27, v6
    s_lshr_b32 s27, s23, 1
    s_lshr_b32 s28, s27, 2
    s_lshl_b32 s28, s28, 1
    s_and_b32 s29, s27, 3
    s_lshl_b32 s29, s29, 3
    s_add_u32 s28, s28, s29
    s_lshl_b32 s28, s28, 7
    s_and_b32 s29, s23, 1
    s_lshl_b32 s29, s29, 3
    s_add_u32 s28, s28, s29
    v_bfe_u32 v6, v1, 4, 1
    v_bfe_u32 v7, v1, 1, 3
    v_lshl_add_u32 v6, v7, 5, v6
    v_lshlrev_b32 v6, 7, v6
    v_and_b32 v7, 1, v1
    v_lshl_add_u32 v6, v7, 2, v6
    v_add_u32 v253, s28, v6
    s_waitcnt lgkmcnt(0)
    s_mov_b32 s8, s4
    s_mov_b32 s9, s5
    s_mov_b32 s10, 50855936
    s_mov_b32 s11, 0x00020000
    s_load_dwordx2 s[12:13], s[0:1], 0
    s_load_dwordx2 s[16:17], s[0:1], 8
    s_load_dwordx2 s[28:29], s[0:1], 64
    s_load_dwordx2 s[72:73], s[0:1], 56
    s_load_dwordx2 s[100:101], s[0:1], 56
    s_load_dwordx2 s[84:85], s[0:1], 16
    s_load_dwordx2 s[86:87], s[0:1], 48
    s_load_dwordx2 s[88:89], s[0:1], 32
    s_load_dwordx2 s[90:91], s[0:1], 40
    s_lshr_b32 s33, s20, 1
    s_lshl_b32 s34, s23, 1
    s_add_u32 s33, s33, s34
    s_and_b32 s34, s20, 1
    s_lshl_b32 s35, s24, 1
    s_add_u32 s34, s34, s35
    s_lshl_b32 s35, s33, 5
    s_lshl_b32 s36, s34, 1
    s_add_u32 s35, s35, s36
    s_lshl_b32 s35, s35, 10
    v_lshlrev_b32 v6, 10, v4
    v_lshl_add_u32 v6, v5, 4, v6
    s_lshl_b32 s36, s33, 15
    s_lshl_b32 s37, s34, 6
    s_add_u32 s36, s36, s37
    s_waitcnt lgkmcnt(0)
    s_mov_b32 s14, 2097152
    s_mov_b32 s15, 0x00020000
    s_mov_b32 s18, 1572864
    s_mov_b32 s19, 0x00020000
    s_mov_b32 s30, 256
    s_mov_b32 s31, 0x00020000
    s_mov_b32 s74, 2097152
    s_mov_b32 s75, 0x00020000
    buffer_load_dwordx4 v[16:19], v6, s[12:15], s36 offen
    buffer_load_dwordx4 v[20:23], v6, s[12:15], s36 offen offset:32
    s_or_b32 s37, s2, s20
    s_cmp_eq_u32 s37, 0
    s_cbranch_scc0 mg_PNOTAG
    s_memrealtime s[38:39]
    s_waitcnt lgkmcnt(0)
    s_or_b32 s38, s38, 1
    v_mov_b32 v8, s38
    v_mov_b32 v9, 0
    s_mov_b64 exec, 1
    buffer_store_dword v8, v9, s[28:31], 0 offen sc1
    s_mov_b64 exec, -1
mg_PNOTAG:
    s_cmp_ge_u32 s2, 96
    s_cbranch_scc1 mg_PNOQ1
    s_mul_i32 s46, s2, 171
    s_lshr_b32 s46, s46, 12
    s_mul_i32 s49, s46, 24
    s_sub_u32 s45, s2, s49
    s_mov_b32 s44, 3072
    v_lshrrev_b32 v10, 3, v1
    v_and_b32 v11, 7, v1
    v_mul_lo_u32 v10, v10, s44
    v_lshl_add_u32 v6, v11, 4, v10
    s_lshl_b32 s50, s46, 7
    s_lshl_b32 s51, s20, 5
    s_add_u32 s50, s50, s51
    s_mul_i32 s51, s50, s44
    s_lshl_b32 s52, s45, 7
    s_add_u32 s51, s51, s52
    s_lshl_b32 s53, s44, 3
    v_bfe_u32 v12, v1, 2, 2
    v_lshl_add_u32 v12, v5, 2, v12
    v_lshlrev_b32 v12, 7, v12
    v_and_b32 v9, 3, v1
    v_lshl_add_u32 v12, v9, 3, v12
    v_bfe_u32 v9, v1, 4, 1
    v_lshl_add_u32 v12, v9, 5, v12
    s_lshl_b32 s54, s20, 13
    s_add_u32 s54, s54, 0
    v_add_u32 v12, s54, v12
    s_add_u32 m0, s54, 0
    s_nop 0
    buffer_load_dwordx4 v6, s[16:19], s51 offen lds
    s_add_u32 s51, s51, s53
    s_add_u32 m0, s54, 1024
    s_nop 0
    buffer_load_dwordx4 v6, s[16:19], s51 offen lds
    s_add_u32 s51, s51, s53
    s_add_u32 m0, s54, 2048
    s_nop 0
    buffer_load_dwordx4 v6, s[16:19], s51 offen lds
    s_add_u32 s51, s51, s53
    s_add_u32 m0, s54, 3072
    s_nop 0
    buffer_load_dwordx4 v6, s[16:19], s51 offen lds
mg_PNOQ1:
    s_cmp_ge_u32 s2, 96
    s_cbranch_scc0 mg_PW4
    s_waitcnt vmcnt(0)
    s_branch mg_PXW
mg_PW4:
    s_waitcnt vmcnt(4)
mg_PXW:
    v_permlane32_swap_b32 v16, v18
    v_permlane32_swap_b32 v17, v19
    v_permlane32_swap_b32 v20, v22
    v_permlane32_swap_b32 v21, v23
    s_add_u32 s36, s35, 0
    s_add_u32 s36, s36, s7
    buffer_store_dwordx4 v[16:19], v3, s[8:11], s36 offen sc1
    buffer_store_dwordx4 v[20:23], v3, s[8:11], s36 offen offset:1024 sc1
    s_mov_b32 s37, 0x3f803f80
    v_mov_b32 v6, 0
    v_mov_b32 v7, 0
    v_dot2c_f32_bf16 v6, s37, v16
    v_dot2c_f32_bf16 v7, v16, v16
    v_dot2c_f32_bf16 v6, s37, v17
    v_dot2c_f32_bf16 v7, v17, v17
    v_dot2c_f32_bf16 v6, s37, v18
    v_dot2c_f32_bf16 v7, v18, v18
    v_dot2c_f32_bf16 v6, s37, v19
    v_dot2c_f32_bf16 v7, v19, v19
    v_dot2c_f32_bf16 v6, s37, v20
    v_dot2c_f32_bf16 v7, v20, v20
    v_dot2c_f32_bf16 v6, s37, v21
    v_dot2c_f32_bf16 v7, v21, v21
    v_dot2c_f32_bf16 v6, s37, v22
    v_dot2c_f32_bf16 v7, v22, v22
    v_dot2c_f32_bf16 v6, s37, v23
    v_dot2c_f32_bf16 v7, v23, v23
    s_nop 2
    v_permlane32_swap_b32 v6, v7
    v_add_f32 v6, v6, v7
    s_lshr_b32 s38, s34, 1
    s_lshl_b32 s38, s38, 15
    s_lshl_b32 s39, s33, 9
    s_add_u32 s38, s38, s39
    s_and_b32 s39, s34, 1
    s_lshl_b32 s39, s39, 3
    s_add_u32 s38, s38, s39
    s_add_u32 s38, s38, 12582912
    s_add_u32 s38, s38, s7
    v_lshlrev_b32 v8, 4, v4
    v_lshl_add_u32 v8, v5, 2, v8
    buffer_store_dword v6, v8, s[8:11], s38 offen sc1
    v_mov_b32 v25, 0
    buffer_load_dword v24, v25, s[28:31], 0 offen sc1
    s_cmp_ge_u32 s2, 96
    s_cbranch_scc1 mg_PNOQ2
    s_mul_i32 s46, s2, 171
    s_lshr_b32 s46, s46, 12
    s_mul_i32 s49, s46, 24
    s_sub_u32 s45, s2, s49
    s_mov_b32 s44, 3072
    v_lshrrev_b32 v10, 3, v1
    v_and_b32 v11, 7, v1
    v_mul_lo_u32 v10, v10, s44
    v_lshl_add_u32 v6, v11, 4, v10
    s_lshl_b32 s50, s46, 7
    s_lshl_b32 s51, s20, 5
    s_add_u32 s50, s50, s51
    s_mul_i32 s51, s50, s44
    s_lshl_b32 s52, s45, 7
    s_add_u32 s51, s51, s52
    s_lshl_b32 s53, s44, 3
    v_bfe_u32 v12, v1, 2, 2
    v_lshl_add_u32 v12, v5, 2, v12
    v_lshlrev_b32 v12, 7, v12
    v_and_b32 v9, 3, v1
    v_lshl_add_u32 v12, v9, 3, v12
    v_bfe_u32 v9, v1, 4, 1
    v_lshl_add_u32 v12, v9, 5, v12
    s_lshl_b32 s54, s20, 13
    s_add_u32 s54, s54, 0
    v_add_u32 v12, s54, v12
    s_waitcnt vmcnt(4)
    ds_read_b64_tr_b16 v[32:33], v12 offset:0
    ds_read_b64_tr_b16 v[34:35], v12 offset:1024
    ds_read_b64_tr_b16 v[36:37], v12 offset:64
    ds_read_b64_tr_b16 v[38:39], v12 offset:1088
    ds_read_b64_tr_b16 v[40:41], v12 offset:2048
    ds_read_b64_tr_b16 v[42:43], v12 offset:3072
    ds_read_b64_tr_b16 v[44:45], v12 offset:2112
    ds_read_b64_tr_b16 v[46:47], v12 offset:3136
    s_lshr_b32 s55, s50, 4
    s_lshl_b32 s59, s45, 1
    s_add_u32 s59, s59, 0
    s_and_b32 s60, s59, 15
    s_lshr_b32 s61, s59, 4
    s_lshl_b32 s60, s60, 5
    s_add_u32 s60, s60, s55
    s_mul_i32 s60, s60, 3
    s_add_u32 s60, s60, s61
    s_lshl_b32 s60, s60, 10
    s_add_u32 s56, s60, 41943040
    s_lshl_b32 s59, s45, 1
    s_add_u32 s59, s59, 1
    s_and_b32 s60, s59, 15
    s_lshr_b32 s61, s59, 4
    s_lshl_b32 s60, s60, 5
    s_add_u32 s60, s60, s55
    s_mul_i32 s60, s60, 3
    s_add_u32 s60, s60, s61
    s_lshl_b32 s60, s60, 10
    s_add_u32 s57, s60, 41943040
    s_mov_b32 s58, 3072
    s_waitcnt lgkmcnt(0)
    buffer_store_dwordx4 v[32:35], v3, s[8:11], s56 offen sc1
    buffer_store_dwordx4 v[36:39], v3, s[8:11], s57 offen sc1
    s_add_u32 s56, s56, s58
    s_add_u32 s57, s57, s58
    buffer_store_dwordx4 v[40:43], v3, s[8:11], s56 offen sc1
    buffer_store_dwordx4 v[44:47], v3, s[8:11], s57 offen sc1
    s_mov_b32 s37, 0x3f803f80
    v_mov_b32 v10, 0
    v_mov_b32 v11, 0
    v_dot2c_f32_bf16 v10, s37, v32
    v_dot2c_f32_bf16 v10, s37, v33
    v_dot2c_f32_bf16 v10, s37, v34
    v_dot2c_f32_bf16 v10, s37, v35
    v_dot2c_f32_bf16 v11, s37, v36
    v_dot2c_f32_bf16 v11, s37, v37
    v_dot2c_f32_bf16 v11, s37, v38
    v_dot2c_f32_bf16 v11, s37, v39
    v_dot2c_f32_bf16 v10, s37, v40
    v_dot2c_f32_bf16 v10, s37, v41
    v_dot2c_f32_bf16 v10, s37, v42
    v_dot2c_f32_bf16 v10, s37, v43
    v_dot2c_f32_bf16 v11, s37, v44
    v_dot2c_f32_bf16 v11, s37, v45
    v_dot2c_f32_bf16 v11, s37, v46
    v_dot2c_f32_bf16 v11, s37, v47
    s_nop 2
    v_permlane32_swap_b32 v10, v11
    v_add_f32 v10, v10, v11
    v_lshlrev_b32 v12, 2, v1
    s_lshl_b32 s59, s20, 8
    v_add_u32 v13, s59, v12
    ds_write_b32 v13, v10 offset:36864
    s_waitcnt lgkmcnt(0)
    s_barrier
    s_cmp_eq_u32 s20, 0
    s_cbranch_scc0 mg_PNOQ2
    ds_read_b32 v48, v12 offset:36864
    ds_read_b32 v49, v12 offset:37120
    ds_read_b32 v50, v12 offset:37376
    ds_read_b32 v51, v12 offset:37632
    s_waitcnt lgkmcnt(0)
    v_add_f32 v48, v48, v49
    v_add_f32 v50, v50, v51
    v_add_f32 v48, v48, v50
    s_lshl_b32 s59, s45, 10
    s_lshl_b32 s60, s46, 2
    s_add_u32 s59, s59, s60
    s_add_u32 s59, s59, 49545216
    buffer_store_dword v48, v3, s[8:11], s59 offen sc1
mg_PNOQ2:
    s_cmp_ge_u32 s2, 96
    s_cbranch_scc0 mg_PIPL
    s_cmp_ge_u32 s2, 208
    s_cbranch_scc0 mg_PIGU
mg_PIPL:
    s_sub_u32 s48, s2, 32
    s_sub_u32 s49, s2, 144
    s_cmp_ge_u32 s2, 208
    s_cselect_b32 s48, s49, s48
    s_cmp_lt_u32 s2, 32
    s_cselect_b32 s48, s2, s48
    s_movk_i32 s76, 112
    s_cselect_b32 s76, 32, s76
    s_mov_b32 s77, 47710208
    s_cselect_b32 s77, 47185920, s77
    s_and_b32 s45, s48, 7
    s_lshr_b32 s46, s48, 3
    s_mov_b32 s44, 1024
    v_lshrrev_b32 v10, 3, v1
    v_and_b32 v11, 7, v1
    v_mul_lo_u32 v10, v10, s44
    v_lshl_add_u32 v6, v11, 4, v10
    s_lshl_b32 s50, s46, 7
    s_lshl_b32 s51, s20, 5
    s_add_u32 s50, s50, s51
    s_mul_i32 s51, s50, s44
    s_lshl_b32 s52, s45, 7
    s_add_u32 s51, s51, s52
    s_lshl_b32 s53, s44, 3
    v_bfe_u32 v12, v1, 2, 2
    v_lshl_add_u32 v12, v5, 2, v12
    v_lshlrev_b32 v12, 7, v12
    v_and_b32 v9, 3, v1
    v_lshl_add_u32 v12, v9, 3, v12
    v_bfe_u32 v9, v1, 4, 1
    v_lshl_add_u32 v12, v9, 5, v12
    s_lshl_b32 s54, s20, 13
    s_add_u32 s54, s54, 0
    v_add_u32 v12, s54, v12
    s_cmp_lt_u32 s2, 32
    s_cselect_b32 s80, s84, s86
    s_cselect_b32 s81, s85, s87
    s_mov_b32 s82, 1835008
    s_cselect_b32 s82, 524288, s82
    s_mov_b32 s83, 0x00020000
    s_add_u32 m0, s54, 0
    s_nop 0
    buffer_load_dwordx4 v6, s[80:83], s51 offen lds
    s_add_u32 s51, s51, s53
    s_add_u32 m0, s54, 1024
    s_nop 0
    buffer_load_dwordx4 v6, s[80:83], s51 offen lds
    s_add_u32 s51, s51, s53
    s_add_u32 m0, s54, 2048
    s_nop 0
    buffer_load_dwordx4 v6, s[80:83], s51 offen lds
    s_add_u32 s51, s51, s53
    s_add_u32 m0, s54, 3072
    s_nop 0
    buffer_load_dwordx4 v6, s[80:83], s51 offen lds
    s_branch mg_PIEND
mg_PIGU:
    s_sub_u32 s48, s2, 96
    s_mul_i32 s46, s48, 147
    s_lshr_b32 s46, s46, 12
    s_mul_i32 s49, s46, 28
    s_sub_u32 s45, s48, s49
    s_mov_b32 s44, 3584
    v_lshrrev_b32 v10, 3, v1
    v_and_b32 v11, 7, v1
    v_mul_lo_u32 v10, v10, s44
    v_lshl_add_u32 v6, v11, 4, v10
    s_lshl_b32 s50, s46, 7
    s_lshl_b32 s51, s20, 5
    s_add_u32 s50, s50, s51
    s_mul_i32 s51, s50, s44
    s_lshl_b32 s52, s45, 7
    s_add_u32 s51, s51, s52
    s_lshl_b32 s53, s44, 3
    v_bfe_u32 v12, v1, 2, 2
    v_lshl_add_u32 v12, v5, 2, v12
    v_lshlrev_b32 v12, 7, v12
    v_and_b32 v9, 3, v1
    v_lshl_add_u32 v12, v9, 3, v12
    v_bfe_u32 v9, v1, 4, 1
    v_lshl_add_u32 v12, v9, 12, v12
    s_lshl_b32 s54, s20, 13
    s_add_u32 s54, s54, 0
    v_add_u32 v12, s54, v12
    s_mov_b32 s80, s88
    s_mov_b32 s81, s89
    s_mov_b32 s82, 1835008
    s_mov_b32 s83, 0x00020000
    s_mov_b32 s92, s90
    s_mov_b32 s93, s91
    s_mov_b32 s94, 1835008
    s_mov_b32 s95, 0x00020000
    s_add_u32 m0, s54, 0
    s_nop 0
    buffer_load_dwordx4 v6, s[80:83], s51 offen lds
    s_add_u32 m0, s54, 4096
    s_nop 0
    buffer_load_dwordx4 v6, s[92:95], s51 offen lds
    s_add_u32 s51, s51, s53
    s_add_u32 m0, s54, 1024
    s_nop 0
    buffer_load_dwordx4 v6, s[80:83], s51 offen lds
    s_add_u32 m0, s54, 5120
    s_nop 0
    buffer_load_dwordx4 v6, s[92:95], s51 offen lds
    s_add_u32 s51, s51, s53
    s_add_u32 m0, s54, 2048
    s_nop 0
    buffer_load_dwordx4 v6, s[80:83], s51 offen lds
    s_add_u32 m0, s54, 6144
    s_nop 0
    buffer_load_dwordx4 v6, s[92:95], s51 offen lds
    s_add_u32 s51, s51, s53
    s_add_u32 m0, s54, 3072
    s_nop 0
    buffer_load_dwordx4 v6, s[80:83], s51 offen lds
    s_add_u32 m0, s54, 7168
    s_nop 0
    buffer_load_dwordx4 v6, s[92:95], s51 offen lds
mg_PIEND:
    s_cmp_ge_u32 s2, 96
    s_cbranch_scc0 mg_PD4
    s_cmp_ge_u32 s2, 208
    s_cbranch_scc1 mg_PD4
    s_waitcnt vmcnt(8)
    s_branch mg_PDD
mg_PD4:
    s_waitcnt vmcnt(4)
mg_PDD:
    s_mov_b32 s62, 20000
mg_T1:
    v_readfirstlane_b32 s6, v24
    s_nop 3
    s_cmp_lg_u32 s6, 0
    s_cbranch_scc1 mg_TD2
    buffer_load_dword v24, v25, s[28:31], 0 offen sc1
    s_waitcnt vmcnt(0)
    s_sub_u32 s62, s62, 1
    s_cmp_lg_u32 s62, 0
    s_cbranch_scc1 mg_T1
mg_TD2:
    s_lshl_b32 s62, s2, 7
    s_lshl_b32 s63, s20, 2
    s_add_u32 s62, s62, s63
    s_add_u32 s63, s62, 50659328
    s_add_u32 s62, s62, s64
    v_mov_b32 v16, s6
    v_mov_b32 v17, 0
    s_mov_b64 exec, 1
    buffer_store_dword v16, v17, s[8:11], s62 offen sc1
    s_cmp_ge_u32 s2, 96
    s_cbranch_scc1 mg_PNOQF
    buffer_store_dword v16, v17, s[8:11], s63 offen sc1
mg_PNOQF:
    s_mov_b64 exec, -1
    s_cmp_ge_u32 s2, 96
    s_cbranch_scc1 mg_PE1
    s_waitcnt vmcnt(2)
    s_branch mg_PEE
mg_PE1:
    s_waitcnt vmcnt(1)
mg_PEE:
    s_cmp_ge_u32 s2, 96
    s_cbranch_scc0 mg_BPL
    s_cmp_ge_u32 s2, 208
    s_cbranch_scc0 mg_BGU
mg_BPL:
    s_sub_u32 s48, s2, 32
    s_sub_u32 s49, s2, 144
    s_cmp_ge_u32 s2, 208
    s_cselect_b32 s48, s49, s48
    s_cmp_lt_u32 s2, 32
    s_cselect_b32 s48, s2, s48
    s_movk_i32 s76, 112
    s_cselect_b32 s76, 32, s76
    s_mov_b32 s77, 47710208
    s_cselect_b32 s77, 47185920, s77
    s_and_b32 s45, s48, 7
    s_lshr_b32 s46, s48, 3
    s_mov_b32 s44, 1024
    v_lshrrev_b32 v10, 3, v1
    v_and_b32 v11, 7, v1
    v_mul_lo_u32 v10, v10, s44
    v_lshl_add_u32 v6, v11, 4, v10
    s_lshl_b32 s50, s46, 7
    s_lshl_b32 s51, s20, 5
    s_add_u32 s50, s50, s51
    s_mul_i32 s51, s50, s44
    s_lshl_b32 s52, s45, 7
    s_add_u32 s51, s51, s52
    s_lshl_b32 s53, s44, 3
    v_bfe_u32 v12, v1, 2, 2
    v_lshl_add_u32 v12, v5, 2, v12
    v_lshlrev_b32 v12, 7, v12
    v_and_b32 v9, 3, v1
    v_lshl_add_u32 v12, v9, 3, v12
    v_bfe_u32 v9, v1, 4, 1
    v_lshl_add_u32 v12, v9, 5, v12
    s_lshl_b32 s54, s20, 13
    s_add_u32 s54, s54, 0
    v_add_u32 v12, s54, v12
    ds_read_b64_tr_b16 v[32:33], v12 offset:0
    ds_read_b64_tr_b16 v[34:35], v12 offset:1024
    ds_read_b64_tr_b16 v[36:37], v12 offset:64
    ds_read_b64_tr_b16 v[38:39], v12 offset:1088
    ds_read_b64_tr_b16 v[40:41], v12 offset:2048
    ds_read_b64_tr_b16 v[42:43], v12 offset:3072
    ds_read_b64_tr_b16 v[44:45], v12 offset:2112
    ds_read_b64_tr_b16 v[46:47], v12 offset:3136
    s_lshr_b32 s55, s50, 4
    s_lshl_b32 s59, s45, 1
    s_add_u32 s59, s59, 0
    s_mul_i32 s60, s59, s76
    s_add_u32 s60, s60, s55
    s_lshl_b32 s60, s60, 10
    s_add_u32 s56, s60, s77
    s_lshl_b32 s59, s45, 1
    s_add_u32 s59, s59, 1
    s_mul_i32 s60, s59, s76
    s_add_u32 s60, s60, s55
    s_lshl_b32 s60, s60, 10
    s_add_u32 s57, s60, s77
    s_mov_b32 s58, 1024
    s_waitcnt lgkmcnt(0)
    buffer_store_dwordx4 v[32:35], v3, s[8:11], s56 offen sc1
    buffer_store_dwordx4 v[36:39], v3, s[8:11], s57 offen sc1
    s_add_u32 s56, s56, s58
    s_add_u32 s57, s57, s58
    buffer_store_dwordx4 v[40:43], v3, s[8:11], s56 offen sc1
    buffer_store_dwordx4 v[44:47], v3, s[8:11], s57 offen sc1
    s_branch mg_BEND
mg_BGU:
    s_sub_u32 s48, s2, 96
    s_mul_i32 s46, s48, 147
    s_lshr_b32 s46, s46, 12
    s_mul_i32 s49, s46, 28
    s_sub_u32 s45, s48, s49
    s_mov_b32 s44, 3584
    v_lshrrev_b32 v10, 3, v1
    v_and_b32 v11, 7, v1
    v_mul_lo_u32 v10, v10, s44
    v_lshl_add_u32 v6, v11, 4, v10
    s_lshl_b32 s50, s46, 7
    s_lshl_b32 s51, s20, 5
    s_add_u32 s50, s50, s51
    s_mul_i32 s51, s50, s44
    s_lshl_b32 s52, s45, 7
    s_add_u32 s51, s51, s52
    s_lshl_b32 s53, s44, 3
    v_bfe_u32 v12, v1, 2, 2
    v_lshl_add_u32 v12, v5, 2, v12
    v_lshlrev_b32 v12, 7, v12
    v_and_b32 v9, 3, v1
    v_lshl_add_u32 v12, v9, 3, v12
    v_bfe_u32 v9, v1, 4, 1
    v_lshl_add_u32 v12, v9, 12, v12
    s_lshl_b32 s54, s20, 13
    s_add_u32 s54, s54, 0
    v_add_u32 v12, s54, v12
    s_lshr_b32 s55, s50, 4
    s_lshl_b32 s59, s45, 2
    s_add_u32 s59, s59, 0
    s_mul_i32 s60, s59, 147
    s_lshr_b32 s60, s60, 10
    s_mul_i32 s61, s60, 7
    s_sub_u32 s61, s59, s61
    s_mul_i32 s62, s55, 3
    s_add_u32 s62, s62, s61
    s_lshl_b32 s63, s61, 5
    s_add_u32 s63, s63, s55
    s_cmp_lt_u32 s61, 3
    s_cselect_b32 s62, s62, s63
    s_movk_i32 s72, 0x400
    s_cselect_b32 s72, 3072, s72
    s_mul_i32 s60, s60, 224
    s_add_u32 s60, s60, s62
    s_lshl_b32 s60, s60, 10
    s_add_u32 s68, s60, 43515904
    s_lshl_b32 s59, s45, 2
    s_add_u32 s59, s59, 1
    s_mul_i32 s60, s59, 147
    s_lshr_b32 s60, s60, 10
    s_mul_i32 s61, s60, 7
    s_sub_u32 s61, s59, s61
    s_mul_i32 s62, s55, 3
    s_add_u32 s62, s62, s61
    s_lshl_b32 s63, s61, 5
    s_add_u32 s63, s63, s55
    s_cmp_lt_u32 s61, 3
    s_cselect_b32 s62, s62, s63
    s_movk_i32 s73, 0x400
    s_cselect_b32 s73, 3072, s73
    s_mul_i32 s60, s60, 224
    s_add_u32 s60, s60, s62
    s_lshl_b32 s60, s60, 10
    s_add_u32 s69, s60, 43515904
    s_lshl_b32 s59, s45, 2
    s_add_u32 s59, s59, 2
    s_mul_i32 s60, s59, 147
    s_lshr_b32 s60, s60, 10
    s_mul_i32 s61, s60, 7
    s_sub_u32 s61, s59, s61
    s_mul_i32 s62, s55, 3
    s_add_u32 s62, s62, s61
    s_lshl_b32 s63, s61, 5
    s_add_u32 s63, s63, s55
    s_cmp_lt_u32 s61, 3
    s_cselect_b32 s62, s62, s63
    s_movk_i32 s74, 0x400
    s_cselect_b32 s74, 3072, s74
    s_mul_i32 s60, s60, 224
    s_add_u32 s60, s60, s62
    s_lshl_b32 s60, s60, 10
    s_add_u32 s70, s60, 43515904
    s_lshl_b32 s59, s45, 2
    s_add_u32 s59, s59, 3
    s_mul_i32 s60, s59, 147
    s_lshr_b32 s60, s60, 10
    s_mul_i32 s61, s60, 7
    s_sub_u32 s61, s59, s61
    s_mul_i32 s62, s55, 3
    s_add_u32 s62, s62, s61
    s_lshl_b32 s63, s61, 5
    s_add_u32 s63, s63, s55
    s_cmp_lt_u32 s61, 3
    s_cselect_b32 s62, s62, s63
    s_movk_i32 s75, 0x400
    s_cselect_b32 s75, 3072, s75
    s_mul_i32 s60, s60, 224
    s_add_u32 s60, s60, s62
    s_lshl_b32 s60, s60, 10
    s_add_u32 s71, s60, 43515904
    ds_read_b64_tr_b16 v[32:33], v12 offset:0
    ds_read_b64_tr_b16 v[34:35], v12 offset:1024
    ds_read_b64_tr_b16 v[36:37], v12 offset:32
    ds_read_b64_tr_b16 v[38:39], v12 offset:1056
    ds_read_b64_tr_b16 v[40:41], v12 offset:64
    ds_read_b64_tr_b16 v[42:43], v12 offset:1088
    ds_read_b64_tr_b16 v[44:45], v12 offset:96
    ds_read_b64_tr_b16 v[46:47], v12 offset:1120
    ds_read_b64_tr_b16 v[48:49], v12 offset:2048
    ds_read_b64_tr_b16 v[50:51], v12 offset:3072
    ds_read_b64_tr_b16 v[52:53], v12 offset:2080
    ds_read_b64_tr_b16 v[54:55], v12 offset:3104
    ds_read_b64_tr_b16 v[56:57], v12 offset:2112
    ds_read_b64_tr_b16 v[58:59], v12 offset:3136
    ds_read_b64_tr_b16 v[60:61], v12 offset:2144
    ds_read_b64_tr_b16 v[62:63], v12 offset:3168
    s_waitcnt lgkmcnt(0)
    buffer_store_dwordx4 v[32:35], v3, s[8:11], s68 offen sc1
    s_add_u32 s68, s68, s72
    buffer_store_dwordx4 v[36:39], v3, s[8:11], s69 offen sc1
    s_add_u32 s69, s69, s73
    buffer_store_dwordx4 v[40:43], v3, s[8:11], s70 offen sc1
    s_add_u32 s70, s70, s74
    buffer_store_dwordx4 v[44:47], v3, s[8:11], s71 offen sc1
    s_add_u32 s71, s71, s75
    buffer_store_dwordx4 v[48:51], v3, s[8:11], s68 offen sc1
    buffer_store_dwordx4 v[52:55], v3, s[8:11], s69 offen sc1
    buffer_store_dwordx4 v[56:59], v3, s[8:11], s70 offen sc1
    buffer_store_dwordx4 v[60:63], v3, s[8:11], s71 offen sc1
    s_mov_b32 s37, 0x3f803f80
    v_mov_b32 v8, 0
    v_mov_b32 v9, 0
    v_mov_b32 v10, 0
    v_mov_b32 v11, 0
    v_dot2c_f32_bf16 v8, s37, v32
    v_dot2c_f32_bf16 v8, s37, v33
    v_dot2c_f32_bf16 v8, s37, v34
    v_dot2c_f32_bf16 v8, s37, v35
    v_dot2c_f32_bf16 v9, s37, v36
    v_dot2c_f32_bf16 v9, s37, v37
    v_dot2c_f32_bf16 v9, s37, v38
    v_dot2c_f32_bf16 v9, s37, v39
    v_dot2c_f32_bf16 v10, s37, v40
    v_dot2c_f32_bf16 v10, s37, v41
    v_dot2c_f32_bf16 v10, s37, v42
    v_dot2c_f32_bf16 v10, s37, v43
    v_dot2c_f32_bf16 v11, s37, v44
    v_dot2c_f32_bf16 v11, s37, v45
    v_dot2c_f32_bf16 v11, s37, v46
    v_dot2c_f32_bf16 v11, s37, v47
    v_dot2c_f32_bf16 v8, s37, v48
    v_dot2c_f32_bf16 v8, s37, v49
    v_dot2c_f32_bf16 v8, s37, v50
    v_dot2c_f32_bf16 v8, s37, v51
    v_dot2c_f32_bf16 v9, s37, v52
    v_dot2c_f32_bf16 v9, s37, v53
    v_dot2c_f32_bf16 v9, s37, v54
    v_dot2c_f32_bf16 v9, s37, v55
    v_dot2c_f32_bf16 v10, s37, v56
    v_dot2c_f32_bf16 v10, s37, v57
    v_dot2c_f32_bf16 v10, s37, v58
    v_dot2c_f32_bf16 v10, s37, v59
    v_dot2c_f32_bf16 v11, s37, v60
    v_dot2c_f32_bf16 v11, s37, v61
    v_dot2c_f32_bf16 v11, s37, v62
    v_dot2c_f32_bf16 v11, s37, v63
    v_permlane32_swap_b32 v8, v9
    s_nop 1
    v_permlane32_swap_b32 v10, v11
    v_add_f32 v8, v8, v9
    v_add_f32 v10, v10, v11
    v_lshlrev_b32 v14, 2, v1
    s_lshl_b32 s59, s20, 9
    v_add_u32 v15, s59, v14
    ds_write_b32 v15, v8 offset:32768
    ds_write_b32 v15, v10 offset:33024
    s_waitcnt lgkmcnt(0)
    s_barrier
    s_cmp_lt_u32 s20, 2
    s_cbranch_scc0 mg_BEND
    s_lshl_b32 s59, s20, 8
    v_add_u32 v15, s59, v14
    ds_read_b32 v16, v15 offset:32768
    ds_read_b32 v17, v15 offset:33280
    ds_read_b32 v18, v15 offset:33792
    ds_read_b32 v19, v15 offset:34304
    s_waitcnt lgkmcnt(0)
    v_add_f32 v16, v16, v17
    v_add_f32 v18, v18, v19
    v_add_f32 v16, v16, v18
    s_lshl_b32 s59, s45, 11
    s_lshl_b32 s60, s20, 10
    s_add_u32 s59, s59, s60
    s_lshl_b32 s60, s46, 2
    s_add_u32 s59, s59, s60
    s_add_u32 s59, s59, 49577984
    buffer_store_dword v16, v3, s[8:11], s59 offen sc1
mg_BEND:
    s_waitcnt vmcnt(0)
    s_barrier
    s_cmp_eq_u32 s20, 0
    s_cbranch_scc0 mg_BNF
    s_lshl_b32 s62, s2, 2
    s_add_u32 s62, s62, 50692096
    v_mov_b32 v16, s6
    v_mov_b32 v17, 0
    s_mov_b64 exec, 1
    buffer_store_dword v16, v17, s[8:11], s62 offen sc1
    s_mov_b64 exec, -1
mg_BNF:
    v_lshrrev_b32 v6, 4, v1
    v_min_u32 v6, 2, v6
    v_lshlrev_b32 v6, 3, v6
    v_bfe_u32 v7, v1, 2, 2
    v_mul_u32_u24 v7, 24, v7
    v_add_u32 v6, v6, v7
    s_lshr_b32 s27, s22, 1
    v_add_u32 v6, s27, v6
    v_lshlrev_b32 v6, 7, v6
    v_and_b32 v7, 3, v1
    v_lshl_add_u32 v6, v7, 2, v6
    s_mov_b32 s65, 50659328
    s_cmp_eq_u32 s20, 0
    s_cbranch_scc0 mg_WD4
    s_mov_b32 s62, 20000
mg_W3:
    buffer_load_dword v16, v6, s[8:11], s65 offen sc1
    buffer_load_dword v17, v250, s[8:11], s64 offen sc1
    s_waitcnt vmcnt(0)
    v_xor_b32 v16, s6, v16
    v_xor_b32 v17, s6, v17
    v_or_b32 v16, v16, v17
    v_cmp_ne_u32 vcc, 0, v16
    s_nop 3
    s_cbranch_vccz mg_WD4
    s_sub_u32 s62, s62, 1
    s_cmp_lg_u32 s62, 0
    s_cbranch_scc1 mg_W3
mg_WD4:
    s_barrier
    v_lshlrev_b32 v7, 4, v4
    s_lshl_b32 s28, s22, 9
    s_add_u32 s28, s28, 49545216
    buffer_load_dwordx4 v[32:35], v7, s[8:11], s28 offen offset:0 sc1
    s_add_u32 s28, s28, 8192
    buffer_load_dwordx4 v[36:39], v7, s[8:11], s28 offen offset:0 sc1
    s_add_u32 s28, s28, 8192
    buffer_load_dwordx4 v[40:43], v7, s[8:11], s28 offen offset:0 sc1
    s_mul_i32 s30, s22, 98304
    s_mul_i32 s31, s20, 24576
    s_add_u32 s30, s30, s31
    s_add_u32 s30, s30, 41943040
    s_add_u32 s31, s31, 65536
    s_add_u32 m0, s31, 0
    s_nop 0
    buffer_load_dwordx4 v3, s[8:11], s30 offen offset:0 sc1 lds
    buffer_load_dwordx4 v3, s[8:11], s30 offen offset:1024 sc1 lds
    buffer_load_dwordx4 v3, s[8:11], s30 offen offset:2048 sc1 lds
    buffer_load_dwordx4 v3, s[8:11], s30 offen offset:3072 sc1 lds
    s_add_u32 s30, s30, 4096
    s_add_u32 m0, s31, 4096
    s_nop 0
    buffer_load_dwordx4 v3, s[8:11], s30 offen offset:0 sc1 lds
    buffer_load_dwordx4 v3, s[8:11], s30 offen offset:1024 sc1 lds
    buffer_load_dwordx4 v3, s[8:11], s30 offen offset:2048 sc1 lds
    buffer_load_dwordx4 v3, s[8:11], s30 offen offset:3072 sc1 lds
    s_add_u32 s30, s30, 4096
    s_add_u32 m0, s31, 8192
    s_nop 0
    buffer_load_dwordx4 v3, s[8:11], s30 offen offset:0 sc1 lds
    buffer_load_dwordx4 v3, s[8:11], s30 offen offset:1024 sc1 lds
    buffer_load_dwordx4 v3, s[8:11], s30 offen offset:2048 sc1 lds
    buffer_load_dwordx4 v3, s[8:11], s30 offen offset:3072 sc1 lds
    s_add_u32 s30, s30, 4096
    s_add_u32 m0, s31, 12288
    s_nop 0
    buffer_load_dwordx4 v3, s[8:11], s30 offen offset:0 sc1 lds
    buffer_load_dwordx4 v3, s[8:11], s30 offen offset:1024 sc1 lds
    buffer_load_dwordx4 v3, s[8:11], s30 offen offset:2048 sc1 lds
    buffer_load_dwordx4 v3, s[8:11], s30 offen offset:3072 sc1 lds
    s_add_u32 s30, s30, 4096
    s_add_u32 m0, s31, 16384
    s_nop 0
    buffer_load_dwordx4 v3, s[8:11], s30 offen offset:0 sc1 lds
    buffer_load_dwordx4 v3, s[8:11], s30 offen offset:1024 sc1 lds
    buffer_load_dwordx4 v3, s[8:11], s30 offen offset:2048 sc1 lds
    buffer_load_dwordx4 v3, s[8:11], s30 offen offset:3072 sc1 lds
    s_add_u32 s30, s30, 4096
    s_add_u32 m0, s31, 20480
    s_nop 0
    buffer_load_dwordx4 v3, s[8:11], s30 offen offset:0 sc1 lds
    buffer_load_dwordx4 v3, s[8:11], s30 offen offset:1024 sc1 lds
    buffer_load_dwordx4 v3, s[8:11], s30 offen offset:2048 sc1 lds
    buffer_load_dwordx4 v3, s[8:11], s30 offen offset:3072 sc1 lds
    s_waitcnt vmcnt(24)
    v_add_f32 v32, v32, v33
    v_add_f32 v34, v34, v35
    v_add_f32 v32, v32, v34
    v_cvt_pk_bf16_f32 v33, v32, v32
    v_and_b32 v33, 0xffff0000, v33
    v_sub_f32 v34, v32, v33
    v_cvt_pk_bf16_f32 v236, v33, v34
    v_mov_b32 v237, v236
    v_mov_b32 v238, 0
    v_mov_b32 v239, 0
    v_add_f32 v36, v36, v37
    v_add_f32 v38, v38, v39
    v_add_f32 v36, v36, v38
    v_cvt_pk_bf16_f32 v37, v36, v36
    v_and_b32 v37, 0xffff0000, v37
    v_sub_f32 v38, v36, v37
    v_cvt_pk_bf16_f32 v240, v37, v38
    v_mov_b32 v241, v240
    v_mov_b32 v242, 0
    v_mov_b32 v243, 0
    v_add_f32 v40, v40, v41
    v_add_f32 v42, v42, v43
    v_add_f32 v40, v40, v42
    v_cvt_pk_bf16_f32 v41, v40, v40
    v_and_b32 v41, 0xffff0000, v41
    v_sub_f32 v42, v40, v41
    v_cvt_pk_bf16_f32 v244, v41, v42
    v_mov_b32 v245, v244
    v_mov_b32 v246, 0
    v_mov_b32 v247, 0
mg_LAYER:
    s_lshl_b32 s27, s21, 2
    s_add_u32 s27, s27, s20
    s_lshl_b32 s32, s27, 15
    s_add_u32 s32, s32, 0
    s_add_u32 s32, s32, s7
    v_add_u32 v8, 65536, v3
    v_add_u32 v9, 0x20000, v3
    s_lshl_b32 s34, s22, 17
    s_lshl_b32 s35, s27, 10
    s_add_u32 s34, s34, s35
    s_add_u32 s34, s34, s7
    s_add_u32 s35, s34, 4194304
    s_add_u32 s36, s35, 65536
    s_add_u32 s37, s34, 6291456
    s_add_u32 s38, s37, 65536
    s_add_u32 s39, s34, 8388608
    v_bfe_u32 v10, v4, 4, 1
    v_lshlrev_b32 v10, 16, v10
    v_lshl_add_u32 v10, v5, 8, v10
    v_and_b32 v11, 15, v4
    v_lshl_add_u32 v10, v11, 4, v10
    s_lshl_b32 s40, s20, 14
    v_lshl_add_u32 v11, v4, 2, s40
    v_lshl_add_u32 v12, v5, 4, s40
    s_cmp_eq_u32 s3, 0
    s_cbranch_scc0 mg_A1L5
    buffer_load_dwordx4 a[0:3], v3, s[8:11], s32 offen offset:0 sc1
    buffer_load_dwordx4 a[4:7], v3, s[8:11], s32 offen offset:1024 sc1
    v_lshlrev_b32 v6, 4, v4
    v_lshl_add_u32 v6, v5, 17, v6
    s_lshl_b32 s28, s27, 9
    s_add_u32 s28, s28, 12582912
    s_add_u32 s28, s28, s7
    buffer_load_dwordx4 v[16:19], v6, s[8:11], s28 offen sc1
    s_add_u32 s28, s28, 32768
    buffer_load_dwordx4 v[20:23], v6, s[8:11], s28 offen sc1
    s_add_u32 s28, s28, 32768
    buffer_load_dwordx4 v[24:27], v6, s[8:11], s28 offen sc1
    s_add_u32 s28, s28, 32768
    buffer_load_dwordx4 v[28:31], v6, s[8:11], s28 offen sc1
    buffer_load_dwordx4 a[8:11], v3, s[8:11], s32 offen offset:2048 sc1
    buffer_load_dwordx4 a[12:15], v3, s[8:11], s32 offen offset:3072 sc1
    s_add_u32 s32, s32, 4096
    buffer_load_dwordx4 a[16:19], v3, s[8:11], s32 offen offset:0 sc1
    buffer_load_dwordx4 a[20:23], v3, s[8:11], s32 offen offset:1024 sc1
    s_waitcnt vmcnt(10)
    s_barrier
    ds_read_b128 v[112:115], v8 offset:0
    ds_read_b128 v[116:119], v8 offset:1024
    ds_read_b128 v[120:123], v8 offset:2048
    ds_read_b128 v[124:127], v8 offset:3072
    ds_read_b128 v[128:131], v8 offset:4096
    ds_read_b128 v[132:135], v8 offset:5120
    s_branch mg_A1G6
mg_A1L5:
    s_waitcnt vmcnt(0)
    s_barrier
    ds_read_b128 v[112:115], v8 offset:0
    ds_read_b128 v[116:119], v8 offset:1024
    ds_read_b128 v[120:123], v8 offset:2048
    ds_read_b128 v[124:127], v8 offset:3072
    ds_read_b128 v[128:131], v8 offset:4096
    ds_read_b128 v[132:135], v8 offset:5120
    s_cmp_eq_u32 s20, 0
    s_cbranch_scc0 mg_WD8
    s_mov_b32 s62, 20000
mg_W7:
    buffer_load_dword v16, v250, s[8:11], s64 offen sc1
    s_waitcnt vmcnt(0)
    v_cmp_ne_u32 vcc, s6, v16
    s_nop 3
    s_cbranch_vccz mg_WD8
    s_sub_u32 s62, s62, 1
    s_cmp_lg_u32 s62, 0
    s_cbranch_scc1 mg_W7
mg_WD8:
    s_waitcnt vmcnt(0)
    s_barrier
    buffer_load_dwordx4 a[0:3], v3, s[8:11], s32 offen offset:0 sc1
    buffer_load_dwordx4 a[4:7], v3, s[8:11], s32 offen offset:1024 sc1
    v_lshlrev_b32 v6, 4, v4
    v_lshl_add_u32 v6, v5, 17, v6
    s_lshl_b32 s28, s27, 9
    s_add_u32 s28, s28, 12582912
    s_add_u32 s28, s28, s7
    buffer_load_dwordx4 v[16:19], v6, s[8:11], s28 offen sc1
    s_add_u32 s28, s28, 32768
    buffer_load_dwordx4 v[20:23], v6, s[8:11], s28 offen sc1
    s_add_u32 s28, s28, 32768
    buffer_load_dwordx4 v[24:27], v6, s[8:11], s28 offen sc1
    s_add_u32 s28, s28, 32768
    buffer_load_dwordx4 v[28:31], v6, s[8:11], s28 offen sc1
    buffer_load_dwordx4 a[8:11], v3, s[8:11], s32 offen offset:2048 sc1
    buffer_load_dwordx4 a[12:15], v3, s[8:11], s32 offen offset:3072 sc1
    s_add_u32 s32, s32, 4096
    buffer_load_dwordx4 a[16:19], v3, s[8:11], s32 offen offset:0 sc1
    buffer_load_dwordx4 a[20:23], v3, s[8:11], s32 offen offset:1024 sc1
mg_A1G6:
    s_waitcnt vmcnt(9)
    s_waitcnt lgkmcnt(4)
    v_mfma_f32_32x32x16_bf16 v[64:79], v[112:115], a[0:3], 0
    ds_read_b128 v[136:139], v8 offset:6144
    buffer_load_dwordx4 a[24:27], v3, s[8:11], s32 offen offset:2048 sc1
    v_mfma_f32_32x32x16_bf16 v[80:95], v[116:119], a[0:3], 0
    ds_read_b128 v[140:143], v8 offset:7168
    s_waitcnt vmcnt(5)
    v_add_f32 v16, v16, v18
    v_add_f32 v17, v17, v19
    v_add_f32 v20, v20, v22
    s_waitcnt lgkmcnt(4)
    v_mfma_f32_32x32x16_bf16 v[96:111], a[0:3], v[120:123], 0
    ds_read_b128 v[112:115], v8 offset:8192
    v_add_f32 v21, v21, v23
    v_add_f32 v24, v24, v26
    v_add_f32 v25, v25, v27
    v_add_f32 v28, v28, v30
    v_mfma_f32_32x32x16_bf16 v[64:79], v[124:127], a[4:7], v[64:79]
    ds_read_b128 v[116:119], v8 offset:9216
    buffer_load_dwordx4 a[28:31], v3, s[8:11], s32 offen offset:3072 sc1
    s_add_u32 s32, s32, 4096
    v_add_f32 v29, v29, v31
    v_add_f32 v16, v16, v20
    v_add_f32 v17, v17, v21
    s_waitcnt lgkmcnt(4)
    v_mfma_f32_32x32x16_bf16 v[80:95], v[128:131], a[4:7], v[80:95]
    ds_read_b128 v[120:123], v8 offset:10240
    v_add_f32 v24, v24, v28
    v_add_f32 v25, v25, v29
    v_add_f32 v16, v16, v24
    v_add_f32 v17, v17, v25
    v_mfma_f32_32x32x16_bf16 v[96:111], a[4:7], v[132:135], v[96:111]
    ds_read_b128 v[124:127], v8 offset:11264
    v_mov_b32 v18, v16
    v_mov_b32 v19, v17
    s_nop 0
    v_permlane32_swap_b32 v16, v18
    v_permlane32_swap_b32 v17, v19
    v_add_f32 v16, v16, v18
    s_waitcnt vmcnt(5)
    s_waitcnt lgkmcnt(4)
    v_mfma_f32_32x32x16_bf16 v[64:79], v[136:139], a[8:11], v[64:79]
    ds_read_b128 v[128:131], v8 offset:12288
    buffer_load_dwordx4 a[32:35], v3, s[8:11], s32 offen offset:0 sc1
    v_add_f32 v17, v17, v19
    v_mul_f32 v16, 0x3b000000, v16
    v_mfma_f32_32x32x16_bf16 v[80:95], v[140:143], a[8:11], v[80:95]
    ds_read_b128 v[132:135], v8 offset:13312
    v_mul_f32 v17, 0x3b000000, v17
    v_fma_f32 v17, -v16, v16, v17
    v_max_f32 v17, 0, v17
    v_add_f32 v17, 0x3727c5ac, v17
    s_waitcnt lgkmcnt(4)
    v_mfma_f32_32x32x16_bf16 v[96:111], a[8:11], v[112:115], v[96:111]
    ds_read_b128 v[136:139], v8 offset:14336
    v_rsq_f32 v60, v17
    v_sub_f32 v18, 0, v16
    v_cvt_pk_bf16_f32 v56, v18, v18
    v_and_b32 v19, 0xffff0000, v56
    s_waitcnt vmcnt(5)
    v_mfma_f32_32x32x16_bf16 v[64:79], v[116:119], a[12:15], v[64:79]
    ds_read_b128 v[140:143], v8 offset:15360
    buffer_load_dwordx4 a[36:39], v3, s[8:11], s32 offen offset:1024 sc1
    v_sub_f32 v19, v18, v19
    v_cvt_pk_bf16_f32 v57, v19, v19
    v_mul_f32 v61, v17, v60
    s_waitcnt lgkmcnt(4)
    v_mfma_f32_32x32x16_bf16 v[80:95], v[120:123], a[12:15], v[80:95]
    ds_read_b128 v[112:115], v8 offset:16384
    v_cmp_gt_u32 vcc, 32, v1
    v_mov_b32 v58, 0
    v_mov_b32 v59, 0
    v_cndmask_b32 v56, 0, v56, vcc
    v_mfma_f32_32x32x16_bf16 v[96:111], a[12:15], v[124:127], v[96:111]
    ds_read_b128 v[116:119], v8 offset:17408
    v_cndmask_b32 v57, 0, v57, vcc
    v_mul_f32 v62, 0x3eb8aa3b, v60
    s_waitcnt vmcnt(5)
    s_waitcnt lgkmcnt(4)
    v_mfma_f32_32x32x16_bf16 v[64:79], v[128:131], a[16:19], v[64:79]
    ds_read_b128 v[120:123], v8 offset:18432
    buffer_load_dwordx4 a[40:43], v3, s[8:11], s32 offen offset:2048 sc1
    v_mfma_f32_32x32x16_bf16 v[80:95], v[132:135], a[16:19], v[80:95]
    ds_read_b128 v[124:127], v8 offset:19456
    s_waitcnt lgkmcnt(4)
    v_mfma_f32_32x32x16_bf16 v[96:111], a[16:19], v[136:139], v[96:111]
    ds_read_b128 v[128:131], v8 offset:20480
    s_waitcnt vmcnt(5)
    v_mfma_f32_32x32x16_bf16 v[64:79], v[140:143], a[20:23], v[64:79]
    ds_read_b128 v[132:135], v8 offset:21504
    buffer_load_dwordx4 a[44:47], v3, s[8:11], s32 offen offset:3072 sc1
    s_add_u32 s32, s32, 4096
    s_waitcnt lgkmcnt(4)
    v_mfma_f32_32x32x16_bf16 v[80:95], v[112:115], a[20:23], v[80:95]
    ds_read_b128 v[136:139], v8 offset:22528
    v_mfma_f32_32x32x16_bf16 v[96:111], a[20:23], v[116:119], v[96:111]
    ds_read_b128 v[140:143], v8 offset:23552
    s_waitcnt vmcnt(5)
    s_waitcnt lgkmcnt(4)
    v_mfma_f32_32x32x16_bf16 v[64:79], v[120:123], a[24:27], v[64:79]
    ds_read_b128 v[112:115], v8 offset:24576
    buffer_load_dwordx4 a[48:51], v3, s[8:11], s32 offen offset:0 sc1
    v_mfma_f32_32x32x16_bf16 v[80:95], v[124:127], a[24:27], v[80:95]
    ds_read_b128 v[116:119], v8 offset:25600
    s_waitcnt lgkmcnt(4)
    v_mfma_f32_32x32x16_bf16 v[96:111], a[24:27], v[128:131], v[96:111]
    ds_read_b128 v[120:123], v8 offset:26624
    v_mfma_f32_32x32x16_bf16 v[64:79], v[236:239], v[56:59], v[64:79]
    v_mfma_f32_32x32x16_bf16 v[80:95], v[240:243], v[56:59], v[80:95]
    v_mfma_f32_32x32x16_bf16 v[96:111], v[56:59], v[244:247], v[96:111]
    s_waitcnt vmcnt(5)
    v_mfma_f32_32x32x16_bf16 v[64:79], v[132:135], a[28:31], v[64:79]
    ds_read_b128 v[124:127], v8 offset:27648
    buffer_load_dwordx4 a[52:55], v3, s[8:11], s32 offen offset:1024 sc1
    s_waitcnt lgkmcnt(4)
    v_mfma_f32_32x32x16_bf16 v[80:95], v[136:139], a[28:31], v[80:95]
    ds_read_b128 v[128:131], v8 offset:28672
    v_mfma_f32_32x32x16_bf16 v[96:111], a[28:31], v[140:143], v[96:111]
    ds_read_b128 v[132:135], v8 offset:29696
    s_waitcnt vmcnt(5)
    s_waitcnt lgkmcnt(4)
    v_mfma_f32_32x32x16_bf16 v[64:79], v[112:115], a[32:35], v[64:79]
    ds_read_b128 v[136:139], v8 offset:30720
    buffer_load_dwordx4 a[56:59], v3, s[8:11], s32 offen offset:2048 sc1
    v_mfma_f32_32x32x16_bf16 v[80:95], v[116:119], a[32:35], v[80:95]
    ds_read_b128 v[140:143], v8 offset:31744
    s_waitcnt lgkmcnt(4)
    v_mfma_f32_32x32x16_bf16 v[96:111], a[32:35], v[120:123], v[96:111]
    ds_read_b128 v[112:115], v8 offset:32768
    ds_write_b32 v11, v60
    ds_read_b128 v[144:147], v12 offset:0
    ds_read_b128 v[148:151], v12 offset:32
    ds_read_b128 v[152:155], v12 offset:64
    ds_read_b128 v[156:159], v12 offset:96
    s_waitcnt vmcnt(5)
    v_mfma_f32_32x32x16_bf16 v[64:79], v[124:127], a[36:39], v[64:79]
    ds_read_b128 v[116:119], v8 offset:33792
    buffer_load_dwordx4 a[60:63], v3, s[8:11], s32 offen offset:3072 sc1
    s_add_u32 s32, s32, 4096
    s_waitcnt lgkmcnt(9)
    v_mfma_f32_32x32x16_bf16 v[80:95], v[128:131], a[36:39], v[80:95]
    ds_read_b128 v[120:123], v8 offset:34816
    v_mfma_f32_32x32x16_bf16 v[96:111], a[36:39], v[132:135], v[96:111]
    ds_read_b128 v[124:127], v8 offset:35840
    s_waitcnt vmcnt(5)
    s_waitcnt lgkmcnt(9)
    v_mfma_f32_32x32x16_bf16 v[64:79], v[136:139], a[40:43], v[64:79]
    ds_read_b128 v[128:131], v8 offset:36864
    buffer_load_dwordx4 a[64:67], v3, s[8:11], s32 offen offset:0 sc1
    v_mfma_f32_32x32x16_bf16 v[80:95], v[140:143], a[40:43], v[80:95]
    ds_read_b128 v[132:135], v8 offset:37888
    s_waitcnt lgkmcnt(4)
    v_mfma_f32_32x32x16_bf16 v[96:111], a[40:43], v[112:115], v[96:111]
    ds_read_b128 v[136:139], v8 offset:38912
    s_waitcnt vmcnt(5)
    v_mfma_f32_32x32x16_bf16 v[64:79], v[116:119], a[44:47], v[64:79]
    ds_read_b128 v[140:143], v8 offset:39936
    buffer_load_dwordx4 a[68:71], v3, s[8:11], s32 offen offset:1024 sc1
    s_waitcnt lgkmcnt(4)
    v_mfma_f32_32x32x16_bf16 v[80:95], v[120:123], a[44:47], v[80:95]
    ds_read_b128 v[112:115], v8 offset:40960
    v_mfma_f32_32x32x16_bf16 v[96:111], a[44:47], v[124:127], v[96:111]
    ds_read_b128 v[116:119], v8 offset:41984
    s_waitcnt vmcnt(5)
    s_waitcnt lgkmcnt(4)
    v_mfma_f32_32x32x16_bf16 v[64:79], v[128:131], a[48:51], v[64:79]
    ds_read_b128 v[120:123], v8 offset:43008
    buffer_load_dwordx4 a[72:75], v3, s[8:11], s32 offen offset:2048 sc1
    v_mfma_f32_32x32x16_bf16 v[80:95], v[132:135], a[48:51], v[80:95]
    ds_read_b128 v[124:127], v8 offset:44032
    s_waitcnt lgkmcnt(4)
    v_mfma_f32_32x32x16_bf16 v[96:111], a[48:51], v[136:139], v[96:111]
    ds_read_b128 v[128:131], v8 offset:45056
    s_waitcnt vmcnt(5)
    v_mfma_f32_32x32x16_bf16 v[64:79], v[140:143], a[52:55], v[64:79]
    ds_read_b128 v[132:135], v8 offset:46080
    buffer_load_dwordx4 a[76:79], v3, s[8:11], s32 offen offset:3072 sc1
    s_add_u32 s32, s32, 4096
    s_waitcnt lgkmcnt(4)
    v_mfma_f32_32x32x16_bf16 v[80:95], v[112:115], a[52:55], v[80:95]
    ds_read_b128 v[136:139], v8 offset:47104
    v_mfma_f32_32x32x16_bf16 v[96:111], a[52:55], v[116:119], v[96:111]
    ds_read_b128 v[140:143], v8 offset:48128
    s_waitcnt vmcnt(5)
    s_waitcnt lgkmcnt(4)
    v_mfma_f32_32x32x16_bf16 v[64:79], v[120:123], a[56:59], v[64:79]
    ds_read_b128 v[112:115], v8 offset:49152
    buffer_load_dwordx4 a[80:83], v3, s[8:11], s32 offen offset:0 sc1
    v_mfma_f32_32x32x16_bf16 v[80:95], v[124:127], a[56:59], v[80:95]
    ds_read_b128 v[116:119], v8 offset:50176
    s_waitcnt lgkmcnt(4)
    v_mfma_f32_32x32x16_bf16 v[96:111], a[56:59], v[128:131], v[96:111]
    ds_read_b128 v[120:123], v8 offset:51200
    s_waitcnt vmcnt(5)
    v_mfma_f32_32x32x16_bf16 v[64:79], v[132:135], a[60:63], v[64:79]
    ds_read_b128 v[124:127], v8 offset:52224
    buffer_load_dwordx4 a[84:87], v3, s[8:11], s32 offen offset:1024 sc1
    s_waitcnt lgkmcnt(4)
    v_mfma_f32_32x32x16_bf16 v[80:95], v[136:139], a[60:63], v[80:95]
    ds_read_b128 v[128:131], v8 offset:53248
    v_mfma_f32_32x32x16_bf16 v[96:111], a[60:63], v[140:143], v[96:111]
    ds_read_b128 v[132:135], v8 offset:54272
    s_waitcnt vmcnt(5)
    s_waitcnt lgkmcnt(4)
    v_mfma_f32_32x32x16_bf16 v[64:79], v[112:115], a[64:67], v[64:79]
    ds_read_b128 v[136:139], v8 offset:55296
    buffer_load_dwordx4 a[88:91], v3, s[8:11], s32 offen offset:2048 sc1
    v_mfma_f32_32x32x16_bf16 v[80:95], v[116:119], a[64:67], v[80:95]
    ds_read_b128 v[140:143], v8 offset:56320
    s_waitcnt lgkmcnt(4)
    v_mfma_f32_32x32x16_bf16 v[96:111], a[64:67], v[120:123], v[96:111]
    ds_read_b128 v[112:115], v8 offset:57344
    s_waitcnt vmcnt(5)
    v_mfma_f32_32x32x16_bf16 v[64:79], v[124:127], a[68:71], v[64:79]
    ds_read_b128 v[116:119], v8 offset:58368
    buffer_load_dwordx4 a[92:95], v3, s[8:11], s32 offen offset:3072 sc1
    s_add_u32 s32, s32, 4096
    s_waitcnt lgkmcnt(4)
    v_mfma_f32_32x32x16_bf16 v[80:95], v[128:131], a[68:71], v[80:95]
    ds_read_b128 v[120:123], v8 offset:59392
    v_mfma_f32_32x32x16_bf16 v[96:111], a[68:71], v[132:135], v[96:111]
    ds_read_b128 v[124:127], v8 offset:60416
    s_waitcnt vmcnt(5)
    s_waitcnt lgkmcnt(4)
    v_mfma_f32_32x32x16_bf16 v[64:79], v[136:139], a[72:75], v[64:79]
    ds_read_b128 v[128:131], v8 offset:61440
    buffer_load_dwordx4 a[96:99], v3, s[8:11], s32 offen offset:0 sc1
    v_mfma_f32_32x32x16_bf16 v[80:95], v[140:143], a[72:75], v[80:95]
    ds_read_b128 v[132:135], v8 offset:62464
    s_waitcnt lgkmcnt(4)
    v_mfma_f32_32x32x16_bf16 v[96:111], a[72:75], v[112:115], v[96:111]
    ds_read_b128 v[136:139], v8 offset:63488
    s_waitcnt vmcnt(5)
    v_mfma_f32_32x32x16_bf16 v[64:79], v[116:119], a[76:79], v[64:79]
    ds_read_b128 v[140:143], v8 offset:64512
    buffer_load_dwordx4 a[100:103], v3, s[8:11], s32 offen offset:1024 sc1
    s_waitcnt lgkmcnt(4)
    v_mfma_f32_32x32x16_bf16 v[80:95], v[120:123], a[76:79], v[80:95]
    ds_read_b128 v[112:115], v9 offset:0
    v_mfma_f32_32x32x16_bf16 v[96:111], a[76:79], v[124:127], v[96:111]
    ds_read_b128 v[116:119], v9 offset:1024
    s_waitcnt vmcnt(5)
    s_waitcnt lgkmcnt(4)
    v_mfma_f32_32x32x16_bf16 v[64:79], v[128:131], a[80:83], v[64:79]
    ds_read_b128 v[120:123], v9 offset:2048
    buffer_load_dwordx4 a[104:107], v3, s[8:11], s32 offen offset:2048 sc1
    v_mfma_f32_32x32x16_bf16 v[80:95], v[132:135], a[80:83], v[80:95]
    ds_read_b128 v[124:127], v9 offset:3072
    s_waitcnt lgkmcnt(4)
    v_mfma_f32_32x32x16_bf16 v[96:111], a[80:83], v[136:139], v[96:111]
    ds_read_b128 v[128:131], v9 offset:4096
    s_waitcnt vmcnt(5)
    v_mfma_f32_32x32x16_bf16 v[64:79], v[140:143], a[84:87], v[64:79]
    ds_read_b128 v[132:135], v9 offset:5120
    buffer_load_dwordx4 a[108:111], v3, s[8:11], s32 offen offset:3072 sc1
    s_add_u32 s32, s32, 4096
    s_waitcnt lgkmcnt(4)
    v_mfma_f32_32x32x16_bf16 v[80:95], v[112:115], a[84:87], v[80:95]
    ds_read_b128 v[136:139], v9 offset:6144
    v_mfma_f32_32x32x16_bf16 v[96:111], a[84:87], v[116:119], v[96:111]
    ds_read_b128 v[140:143], v9 offset:7168
    s_waitcnt vmcnt(5)
    s_waitcnt lgkmcnt(4)
    v_mfma_f32_32x32x16_bf16 v[64:79], v[120:123], a[88:91], v[64:79]
    ds_read_b128 v[112:115], v9 offset:8192
    buffer_load_dwordx4 a[112:115], v3, s[8:11], s32 offen offset:0 sc1
    v_mfma_f32_32x32x16_bf16 v[80:95], v[124:127], a[88:91], v[80:95]
    ds_read_b128 v[116:119], v9 offset:9216
    s_waitcnt lgkmcnt(4)
    v_mfma_f32_32x32x16_bf16 v[96:111], a[88:91], v[128:131], v[96:111]
    ds_read_b128 v[120:123], v9 offset:10240
    s_waitcnt vmcnt(5)
    v_mfma_f32_32x32x16_bf16 v[64:79], v[132:135], a[92:95], v[64:79]
    ds_read_b128 v[124:127], v9 offset:11264
    buffer_load_dwordx4 a[116:119], v3, s[8:11], s32 offen offset:1024 sc1
    s_waitcnt lgkmcnt(4)
    v_mfma_f32_32x32x16_bf16 v[80:95], v[136:139], a[92:95], v[80:95]
    ds_read_b128 v[128:131], v9 offset:12288
    v_mfma_f32_32x32x16_bf16 v[96:111], a[92:95], v[140:143], v[96:111]
    ds_read_b128 v[132:135], v9 offset:13312
    s_waitcnt vmcnt(5)
    s_waitcnt lgkmcnt(4)
    v_mfma_f32_32x32x16_bf16 v[64:79], v[112:115], a[96:99], v[64:79]
    ds_read_b128 v[136:139], v9 offset:14336
    buffer_load_dwordx4 a[120:123], v3, s[8:11], s32 offen offset:2048 sc1
    v_mfma_f32_32x32x16_bf16 v[80:95], v[116:119], a[96:99], v[80:95]
    ds_read_b128 v[140:143], v9 offset:15360
    s_waitcnt lgkmcnt(4)
    v_mfma_f32_32x32x16_bf16 v[96:111], a[96:99], v[120:123], v[96:111]
    ds_read_b128 v[112:115], v9 offset:16384
    s_waitcnt vmcnt(5)
    v_mfma_f32_32x32x16_bf16 v[64:79], v[124:127], a[100:103], v[64:79]
    ds_read_b128 v[116:119], v9 offset:17408
    buffer_load_dwordx4 a[124:127], v3, s[8:11], s32 offen offset:3072 sc1
    s_waitcnt lgkmcnt(4)
    v_mfma_f32_32x32x16_bf16 v[80:95], v[128:131], a[100:103], v[80:95]
    ds_read_b128 v[120:123], v9 offset:18432
    v_mfma_f32_32x32x16_bf16 v[96:111], a[100:103], v[132:135], v[96:111]
    ds_read_b128 v[124:127], v9 offset:19456
    s_waitcnt vmcnt(5)
    s_waitcnt lgkmcnt(4)
    v_mfma_f32_32x32x16_bf16 v[64:79], v[136:139], a[104:107], v[64:79]
    ds_read_b128 v[128:131], v9 offset:20480
    v_mfma_f32_32x32x16_bf16 v[80:95], v[140:143], a[104:107], v[80:95]
    ds_read_b128 v[132:135], v9 offset:21504
    s_waitcnt lgkmcnt(4)
    v_mfma_f32_32x32x16_bf16 v[96:111], a[104:107], v[112:115], v[96:111]
    ds_read_b128 v[136:139], v9 offset:22528
    s_waitcnt vmcnt(4)
    v_mfma_f32_32x32x16_bf16 v[64:79], v[116:119], a[108:111], v[64:79]
    ds_read_b128 v[140:143], v9 offset:23552
    s_waitcnt lgkmcnt(4)
    v_mfma_f32_32x32x16_bf16 v[80:95], v[120:123], a[108:111], v[80:95]
    ds_read_b128 v[112:115], v9 offset:24576
    v_mfma_f32_32x32x16_bf16 v[96:111], a[108:111], v[124:127], v[96:111]
    ds_read_b128 v[116:119], v9 offset:25600
    s_waitcnt vmcnt(3)
    s_waitcnt lgkmcnt(4)
    v_mfma_f32_32x32x16_bf16 v[64:79], v[128:131], a[112:115], v[64:79]
    ds_read_b128 v[120:123], v9 offset:26624
    v_mfma_f32_32x32x16_bf16 v[80:95], v[132:135], a[112:115], v[80:95]
    ds_read_b128 v[124:127], v9 offset:27648
    s_waitcnt lgkmcnt(4)
    v_mfma_f32_32x32x16_bf16 v[96:111], a[112:115], v[136:139], v[96:111]
    ds_read_b128 v[128:131], v9 offset:28672
    s_waitcnt vmcnt(2)
    v_mfma_f32_32x32x16_bf16 v[64:79], v[140:143], a[116:119], v[64:79]
    ds_read_b128 v[132:135], v9 offset:29696
    s_waitcnt lgkmcnt(4)
    v_mfma_f32_32x32x16_bf16 v[80:95], v[112:115], a[116:119], v[80:95]
    ds_read_b128 v[136:139], v9 offset:30720
    v_mfma_f32_32x32x16_bf16 v[96:111], a[116:119], v[116:119], v[96:111]
    ds_read_b128 v[140:143], v9 offset:31744
    s_waitcnt vmcnt(1)
    s_waitcnt lgkmcnt(4)
    v_mfma_f32_32x32x16_bf16 v[64:79], v[120:123], a[120:123], v[64:79]
    v_mfma_f32_32x32x16_bf16 v[80:95], v[124:127], a[120:123], v[80:95]
    s_waitcnt lgkmcnt(2)
    v_mfma_f32_32x32x16_bf16 v[96:111], a[120:123], v[128:131], v[96:111]
    s_waitcnt vmcnt(0)
    v_mfma_f32_32x32x16_bf16 v[64:79], v[132:135], a[124:127], v[64:79]
    s_waitcnt lgkmcnt(0)
    v_mfma_f32_32x32x16_bf16 v[80:95], v[136:139], a[124:127], v[80:95]
    v_mfma_f32_32x32x16_bf16 v[96:111], a[124:127], v[140:143], v[96:111]
    s_barrier
    s_nop 7
    v_pk_mul_f32 v[64:65], v[64:65], v[62:63] op_sel_hi:[1,0]
    v_pk_mul_f32 v[66:67], v[66:67], v[62:63] op_sel_hi:[1,0]
    v_pk_mul_f32 v[68:69], v[68:69], v[62:63] op_sel_hi:[1,0]
    v_pk_mul_f32 v[70:71], v[70:71], v[62:63] op_sel_hi:[1,0]
    v_pk_mul_f32 v[72:73], v[72:73], v[62:63] op_sel_hi:[1,0]
    v_pk_mul_f32 v[74:75], v[74:75], v[62:63] op_sel_hi:[1,0]
    v_pk_mul_f32 v[76:77], v[76:77], v[62:63] op_sel_hi:[1,0]
    v_pk_mul_f32 v[78:79], v[78:79], v[62:63] op_sel_hi:[1,0]
    v_cvt_pk_bf16_f32 v112, v64, v65
    v_cvt_pk_bf16_f32 v113, v66, v67
    v_cvt_pk_bf16_f32 v114, v68, v69
    v_cvt_pk_bf16_f32 v115, v70, v71
    v_cvt_pk_bf16_f32 v116, v72, v73
    v_cvt_pk_bf16_f32 v117, v74, v75
    v_cvt_pk_bf16_f32 v118, v76, v77
    v_cvt_pk_bf16_f32 v119, v78, v79
    buffer_store_dwordx4 v[112:115], v3, s[8:11], s35 offen sc1
    buffer_store_dwordx4 v[116:119], v3, s[8:11], s36 offen sc1
    v_pk_mul_f32 v[80:81], v[80:81], v[60:61] op_sel_hi:[1,0]
    v_pk_mul_f32 v[82:83], v[82:83], v[60:61] op_sel_hi:[1,0]
    v_pk_mul_f32 v[84:85], v[84:85], v[60:61] op_sel_hi:[1,0]
    v_pk_mul_f32 v[86:87], v[86:87], v[60:61] op_sel_hi:[1,0]
    v_pk_mul_f32 v[88:89], v[88:89], v[60:61] op_sel_hi:[1,0]
    v_pk_mul_f32 v[90:91], v[90:91], v[60:61] op_sel_hi:[1,0]
    v_pk_mul_f32 v[92:93], v[92:93], v[60:61] op_sel_hi:[1,0]
    v_pk_mul_f32 v[94:95], v[94:95], v[60:61] op_sel_hi:[1,0]
    v_cvt_pk_bf16_f32 v120, v80, v81
    v_cvt_pk_bf16_f32 v121, v82, v83
    v_cvt_pk_bf16_f32 v122, v84, v85
    v_cvt_pk_bf16_f32 v123, v86, v87
    v_cvt_pk_bf16_f32 v124, v88, v89
    v_cvt_pk_bf16_f32 v125, v90, v91
    v_cvt_pk_bf16_f32 v126, v92, v93
    v_cvt_pk_bf16_f32 v127, v94, v95
    buffer_store_dwordx4 v[120:123], v3, s[8:11], s37 offen sc1
    buffer_store_dwordx4 v[124:127], v3, s[8:11], s38 offen sc1
    v_pk_mul_f32 v[96:97], v[96:97], v[144:145]
    v_pk_mul_f32 v[98:99], v[98:99], v[146:147]
    v_pk_mul_f32 v[100:101], v[100:101], v[148:149]
    v_pk_mul_f32 v[102:103], v[102:103], v[150:151]
    v_pk_mul_f32 v[104:105], v[104:105], v[152:153]
    v_pk_mul_f32 v[106:107], v[106:107], v[154:155]
    v_pk_mul_f32 v[108:109], v[108:109], v[156:157]
    v_pk_mul_f32 v[110:111], v[110:111], v[158:159]
    v_cvt_pk_bf16_f32 v128, v96, v97
    v_cvt_pk_bf16_f32 v129, v98, v99
    v_cvt_pk_bf16_f32 v130, v100, v101
    v_cvt_pk_bf16_f32 v131, v102, v103
    v_cvt_pk_bf16_f32 v132, v104, v105
    v_cvt_pk_bf16_f32 v133, v106, v107
    v_cvt_pk_bf16_f32 v134, v108, v109
    v_cvt_pk_bf16_f32 v135, v110, v111
    buffer_store_dwordx4 v[128:131], v10, s[8:11], s39 offen sc1
    buffer_store_dwordx4 v[132:135], v10, s[8:11], s39 offen offset:512 sc1
    s_add_u32 s65, s64, 32768
    s_waitcnt vmcnt(0)
    s_lshl_b32 s62, s2, 7
    s_lshl_b32 s63, s20, 2
    s_add_u32 s62, s62, s63
    s_add_u32 s62, s62, s65
    v_mov_b32 v16, s6
    v_mov_b32 v17, 0
    s_mov_b64 exec, 1
    buffer_store_dword v16, v17, s[8:11], s62 offen sc1
    s_mov_b64 exec, -1
    v_and_b32 v16, 27, v4
    v_cmp_eq_u32 vcc, 16, v16
    v_mov_b32 v17, 0x3f803f80
    s_nop 0
    v_cndmask_b32 v16, 0, v17, vcc
    v_accvgpr_write_b32 a64, v16
    v_accvgpr_write_b32 a65, v16
    v_accvgpr_write_b32 a66, v16
    v_accvgpr_write_b32 a67, v16
    v_accvgpr_write_b32 a68, v16
    v_accvgpr_write_b32 a69, v16
    v_accvgpr_write_b32 a70, v16
    v_accvgpr_write_b32 a71, v16
    v_accvgpr_write_b32 a72, v16
    v_accvgpr_write_b32 a73, v16
    v_accvgpr_write_b32 a74, v16
    v_accvgpr_write_b32 a75, v16
    v_accvgpr_write_b32 a76, v16
    v_accvgpr_write_b32 a77, v16
    v_accvgpr_write_b32 a78, v16
    v_accvgpr_write_b32 a79, v16
    v_accvgpr_write_b32 a80, v16
    v_accvgpr_write_b32 a81, v16
    v_accvgpr_write_b32 a82, v16
    v_accvgpr_write_b32 a83, v16
    v_accvgpr_write_b32 a84, v16
    v_accvgpr_write_b32 a85, v16
    v_accvgpr_write_b32 a86, v16
    v_accvgpr_write_b32 a87, v16
    v_accvgpr_write_b32 a88, v16
    v_accvgpr_write_b32 a89, v16
    v_accvgpr_write_b32 a90, v16
    v_accvgpr_write_b32 a91, v16
    v_accvgpr_write_b32 a92, v16
    v_accvgpr_write_b32 a93, v16
    v_accvgpr_write_b32 a94, v16
    v_accvgpr_write_b32 a95, v16
    v_accvgpr_write_b32 a96, v16
    v_accvgpr_write_b32 a97, v16
    v_accvgpr_write_b32 a98, v16
    v_accvgpr_write_b32 a99, v16
    v_accvgpr_write_b32 a100, v16
    v_accvgpr_write_b32 a101, v16
    v_accvgpr_write_b32 a102, v16
    v_accvgpr_write_b32 a103, v16
    v_accvgpr_write_b32 a104, v16
    v_accvgpr_write_b32 a105, v16
    v_accvgpr_write_b32 a106, v16
    v_accvgpr_write_b32 a107, v16
    v_accvgpr_write_b32 a108, v16
    v_accvgpr_write_b32 a109, v16
    v_accvgpr_write_b32 a110, v16
    v_accvgpr_write_b32 a111, v16
    v_accvgpr_write_b32 a112, v16
    v_accvgpr_write_b32 a113, v16
    v_accvgpr_write_b32 a114, v16
    v_accvgpr_write_b32 a115, v16
    v_accvgpr_write_b32 a116, v16
    v_accvgpr_write_b32 a117, v16
    v_accvgpr_write_b32 a118, v16
    v_accvgpr_write_b32 a119, v16
    v_accvgpr_write_b32 a120, v16
    v_accvgpr_write_b32 a121, v16
    v_accvgpr_write_b32 a122, v16
    v_accvgpr_write_b32 a123, v16
    v_accvgpr_write_b32 a124, v16
    v_accvgpr_write_b32 a125, v16
    v_accvgpr_write_b32 a126, v16
    v_accvgpr_write_b32 a127, v16
    v_accvgpr_write_b32 a128, v16
    v_accvgpr_write_b32 a129, v16
    v_accvgpr_write_b32 a130, v16
    v_accvgpr_write_b32 a131, v16
    v_accvgpr_write_b32 a132, v16
    v_accvgpr_write_b32 a133, v16
    v_accvgpr_write_b32 a134, v16
    v_accvgpr_write_b32 a135, v16
    v_accvgpr_write_b32 a136, v16
    v_accvgpr_write_b32 a137, v16
    v_accvgpr_write_b32 a138, v16
    v_accvgpr_write_b32 a139, v16
    v_accvgpr_write_b32 a140, v16
    v_accvgpr_write_b32 a141, v16
    v_accvgpr_write_b32 a142, v16
    v_accvgpr_write_b32 a143, v16
    v_accvgpr_write_b32 a144, v16
    v_accvgpr_write_b32 a145, v16
    v_accvgpr_write_b32 a146, v16
    v_accvgpr_write_b32 a147, v16
    v_accvgpr_write_b32 a148, v16
    v_accvgpr_write_b32 a149, v16
    v_accvgpr_write_b32 a150, v16
    v_accvgpr_write_b32 a151, v16
    v_accvgpr_write_b32 a152, v16
    v_accvgpr_write_b32 a153, v16
    v_accvgpr_write_b32 a154, v16
    v_accvgpr_write_b32 a155, v16
    v_accvgpr_write_b32 a156, v16
    v_accvgpr_write_b32 a157, v16
    v_accvgpr_write_b32 a158, v16
    v_accvgpr_write_b32 a159, v16
    v_accvgpr_write_b32 a160, v16
    v_accvgpr_write_b32 a161, v16
    v_accvgpr_write_b32 a162, v16
    v_accvgpr_write_b32 a163, v16
    v_accvgpr_write_b32 a164, v16
    v_accvgpr_write_b32 a165, v16
    v_accvgpr_write_b32 a166, v16
    v_accvgpr_write_b32 a167, v16
    v_accvgpr_write_b32 a168, v16
    v_accvgpr_write_b32 a169, v16
    v_accvgpr_write_b32 a170, v16
    v_accvgpr_write_b32 a171, v16
    v_accvgpr_write_b32 a172, v16
    v_accvgpr_write_b32 a173, v16
    v_accvgpr_write_b32 a174, v16
    v_accvgpr_write_b32 a175, v16
    v_accvgpr_write_b32 a176, v16
    v_accvgpr_write_b32 a177, v16
    v_accvgpr_write_b32 a178, v16
    v_accvgpr_write_b32 a179, v16
    v_accvgpr_write_b32 a180, v16
    v_accvgpr_write_b32 a181, v16
    v_accvgpr_write_b32 a182, v16
    v_accvgpr_write_b32 a183, v16
    v_accvgpr_write_b32 a184, v16
    v_accvgpr_write_b32 a185, v16
    v_accvgpr_write_b32 a186, v16
    v_accvgpr_write_b32 a187, v16
    v_accvgpr_write_b32 a188, v16
    v_accvgpr_write_b32 a189, v16
    v_accvgpr_write_b32 a190, v16
    v_accvgpr_write_b32 a191, v16
    s_lshl_b32 s27, s25, 16
    s_add_u32 s27, s27, s7
    s_lshl_b32 s28, s26, 13
    s_add_u32 s28, s28, s27
    s_add_u32 s28, s28, 4194304
    s_add_u32 s50, s28, 7168
    s_lshl_b32 s29, s20, 14
    s_add_u32 s29, s29, s27
    s_add_u32 s30, s29, 6291456
    s_add_u32 s31, s29, 8388608
    v_and_b32 v6, 15, v4
    v_lshlrev_b32 v6, 4, v6
    v_lshl_add_u32 v6, v5, 8, v6
    s_mov_b32 s32, 0x0000ffff
    s_mov_b32 s33, 0x0000ffff
    s_mul_i32 s34, s20, 2304
    s_add_u32 s34, s34, 0
    v_add_u32 v8, s34, v3
    v_lshl_add_u32 v9, v1, 2, s34
    s_lshl_b32 s40, s24, 16
    s_lshl_b32 s41, s20, 13
    s_add_u32 s40, s40, s41
    s_add_u32 s40, s40, 47185920
    s_add_u32 s41, s40, 32768
    s_and_b32 s46, s20, 1
    s_lshl_b32 s46, s46, 15
    s_sub_u32 s41, s41, s46
    s_add_u32 s40, s40, s46
    s_mul_i32 s44, s22, 229376
    s_lshl_b32 s45, s20, 12
    s_add_u32 s44, s44, s45
    s_add_u32 s44, s44, 43515904
    s_add_u32 s65, s64, 32768
    s_cmp_eq_u32 s20, 0
    s_cbranch_scc0 mg_WD10
    s_mov_b32 s62, 20000
mg_W9:
    buffer_load_dwordx4 v[16:19], v251, s[8:11], s65 offen sc1
    s_waitcnt vmcnt(0)
    v_xor_b32 v16, s6, v16
    v_xor_b32 v17, s6, v17
    v_xor_b32 v18, s6, v18
    v_xor_b32 v19, s6, v19
    v_or3_b32 v16, v16, v17, v18
    v_or_b32 v16, v16, v19
    v_cmp_ne_u32 vcc, 0, v16
    s_nop 3
    s_cbranch_vccz mg_WD10
    s_sub_u32 s62, s62, 1
    s_cmp_lg_u32 s62, 0
    s_cbranch_scc1 mg_W9
mg_WD10:
    s_waitcnt vmcnt(0)
    s_barrier
    buffer_load_dwordx4 v[168:171], v3, s[8:11], s28 offen sc1
    s_add_u32 s28, s28, 1024
    buffer_load_dwordx4 a[0:3], v3, s[8:11], s30 offen offset:0 sc1
    buffer_load_dwordx4 a[4:7], v3, s[8:11], s30 offen offset:1024 sc1
    buffer_load_dwordx4 a[8:11], v3, s[8:11], s30 offen offset:2048 sc1
    s_mov_b64 exec, s[32:33]
    buffer_load_dwordx4 a[64:67], v6, s[8:11], s31 offen offset:0 sc1
    buffer_load_dwordx4 a[68:71], v6, s[8:11], s31 offen offset:512 sc1
    s_mov_b64 exec, -1
    buffer_load_dwordx4 a[12:15], v3, s[8:11], s30 offen offset:3072 sc1
    s_add_u32 s30, s30, 4096
    s_mov_b64 exec, s[32:33]
    buffer_load_dwordx4 a[72:75], v6, s[8:11], s31 offen offset:1024 sc1
    buffer_load_dwordx4 a[76:79], v6, s[8:11], s31 offen offset:1536 sc1
    s_mov_b64 exec, -1
    buffer_load_dwordx4 a[16:19], v3, s[8:11], s30 offen offset:0 sc1
    s_mov_b64 exec, s[32:33]
    buffer_load_dwordx4 a[80:83], v6, s[8:11], s31 offen offset:2048 sc1
    buffer_load_dwordx4 a[84:87], v6, s[8:11], s31 offen offset:2560 sc1
    s_mov_b64 exec, -1
    s_mov_b32 s46, 50692096
    s_waitcnt vmcnt(10)
    v_mfma_f32_32x32x16_bf16 v[64:79], a[0:3], v[168:171], 0
    s_nop 7
    s_nop 3
    v_exp_f32 v64, v64
    v_exp_f32 v65, v65
    v_exp_f32 v66, v66
    v_exp_f32 v67, v67
    v_exp_f32 v68, v68
    s_waitcnt vmcnt(9)
    v_mfma_f32_32x32x16_bf16 v[80:95], a[4:7], v[168:171], 0
    v_exp_f32 v69, v69
    v_exp_f32 v70, v70
    v_exp_f32 v71, v71
    v_exp_f32 v72, v72
    v_exp_f32 v73, v73
    buffer_load_dwordx4 a[20:23], v3, s[8:11], s30 offen offset:1024 sc1
    buffer_load_dwordx4 v[172:175], v3, s[8:11], s28 offen sc1
    s_add_u32 s28, s28, 1024
    v_exp_f32 v74, v74
    v_exp_f32 v75, v75
    v_exp_f32 v76, v76
    s_mov_b64 exec, s[32:33]
    buffer_load_dwordx4 a[88:91], v6, s[8:11], s31 offen offset:3072 sc1
    buffer_load_dwordx4 a[92:95], v6, s[8:11], s31 offen offset:3584 sc1
    s_mov_b64 exec, -1
    s_add_u32 s31, s31, 4096
    v_exp_f32 v77, v77
    v_exp_f32 v78, v78
    v_exp_f32 v79, v79
    v_exp_f32 v80, v80
    v_cvt_pk_bf16_f32 v160, v64, v65
    v_exp_f32 v81, v81
    v_cvt_pk_bf16_f32 v161, v66, v67
    v_exp_f32 v82, v82
    v_cvt_pk_bf16_f32 v162, v68, v69
    v_exp_f32 v83, v83
    v_cvt_pk_bf16_f32 v163, v70, v71
    v_exp_f32 v84, v84
    s_waitcnt vmcnt(12)
    v_mfma_f32_32x32x16_bf16 v[96:111], a[8:11], v[168:171], 0
    v_exp_f32 v85, v85
    v_cvt_pk_bf16_f32 v164, v72, v73
    v_exp_f32 v86, v86
    v_cvt_pk_bf16_f32 v165, v74, v75
    v_exp_f32 v87, v87
    v_cvt_pk_bf16_f32 v166, v76, v77
    v_exp_f32 v88, v88
    v_cvt_pk_bf16_f32 v167, v78, v79
    v_exp_f32 v89, v89
    s_waitcnt vmcnt(10)
    v_mfma_f32_32x32x16_bf16 v[128:143], a[64:67], v[160:163], 0
    buffer_load_dwordx4 a[24:27], v3, s[8:11], s30 offen offset:2048 sc1
    v_exp_f32 v90, v90
    v_exp_f32 v91, v91
    v_exp_f32 v92, v92
    v_mfma_f32_32x32x16_bf16 v[128:143], a[68:71], v[164:167], v[128:143]
    s_mov_b64 exec, s[32:33]
    buffer_load_dwordx4 a[96:99], v6, s[8:11], s31 offen offset:0 sc1
    buffer_load_dwordx4 a[100:103], v6, s[8:11], s31 offen offset:512 sc1
    s_mov_b64 exec, -1
    v_exp_f32 v93, v93
    v_exp_f32 v94, v94
    v_exp_f32 v95, v95
    v_exp_f32 v96, v96
    v_cvt_pk_bf16_f32 v160, v80, v81
    v_exp_f32 v97, v97
    v_cvt_pk_bf16_f32 v161, v82, v83
    v_exp_f32 v98, v98
    v_cvt_pk_bf16_f32 v162, v84, v85
    v_exp_f32 v99, v99
    v_cvt_pk_bf16_f32 v163, v86, v87
    v_exp_f32 v100, v100
    s_waitcnt vmcnt(12)
    v_mfma_f32_32x32x16_bf16 v[112:127], a[12:15], v[168:171], 0
    v_exp_f32 v101, v101
    v_cvt_pk_bf16_f32 v164, v88, v89
    v_exp_f32 v102, v102
    v_cvt_pk_bf16_f32 v165, v90, v91
    v_exp_f32 v103, v103
    v_cvt_pk_bf16_f32 v166, v92, v93
    v_exp_f32 v104, v104
    v_cvt_pk_bf16_f32 v167, v94, v95
    v_exp_f32 v105, v105
    s_waitcnt vmcnt(10)
    v_mfma_f32_32x32x16_bf16 v[128:143], a[72:75], v[160:163], v[128:143]
    buffer_load_dwordx4 a[28:31], v3, s[8:11], s30 offen offset:3072 sc1
    s_add_u32 s30, s30, 4096
    v_exp_f32 v106, v106
    v_exp_f32 v107, v107
    v_exp_f32 v108, v108
    v_mfma_f32_32x32x16_bf16 v[128:143], a[76:79], v[164:167], v[128:143]
    s_mov_b64 exec, s[32:33]
    buffer_load_dwordx4 a[104:107], v6, s[8:11], s31 offen offset:1024 sc1
    buffer_load_dwordx4 a[108:111], v6, s[8:11], s31 offen offset:1536 sc1
    s_mov_b64 exec, -1
    v_exp_f32 v109, v109
    v_exp_f32 v110, v110
    v_exp_f32 v111, v111
    v_exp_f32 v112, v112
    v_cvt_pk_bf16_f32 v160, v96, v97
    v_exp_f32 v113, v113
    v_cvt_pk_bf16_f32 v161, v98, v99
    v_exp_f32 v114, v114
    v_cvt_pk_bf16_f32 v162, v100, v101
    v_exp_f32 v115, v115
    v_cvt_pk_bf16_f32 v163, v102, v103
    v_exp_f32 v116, v116
    s_waitcnt vmcnt(12)
    v_mfma_f32_32x32x16_bf16 v[64:79], a[16:19], v[168:171], 0
    v_exp_f32 v117, v117
    v_cvt_pk_bf16_f32 v164, v104, v105
    v_exp_f32 v118, v118
    v_cvt_pk_bf16_f32 v165, v106, v107
    v_exp_f32 v119, v119
    v_cvt_pk_bf16_f32 v166, v108, v109
    v_exp_f32 v120, v120
    v_cvt_pk_bf16_f32 v167, v110, v111
    v_exp_f32 v121, v121
    s_waitcnt vmcnt(10)
    v_mfma_f32_32x32x16_bf16 v[128:143], a[80:83], v[160:163], v[128:143]
    buffer_load_dwordx4 a[32:35], v3, s[8:11], s30 offen offset:0 sc1
    v_exp_f32 v122, v122
    v_exp_f32 v123, v123
    v_exp_f32 v124, v124
    v_mfma_f32_32x32x16_bf16 v[128:143], a[84:87], v[164:167], v[128:143]
    s_mov_b64 exec, s[32:33]
    buffer_load_dwordx4 a[112:115], v6, s[8:11], s31 offen offset:2048 sc1
    buffer_load_dwordx4 a[116:119], v6, s[8:11], s31 offen offset:2560 sc1
    s_mov_b64 exec, -1
    v_exp_f32 v125, v125
    v_exp_f32 v126, v126
    v_exp_f32 v127, v127
    v_exp_f32 v64, v64
    v_cvt_pk_bf16_f32 v160, v112, v113
    v_exp_f32 v65, v65
    v_cvt_pk_bf16_f32 v161, v114, v115
    v_exp_f32 v66, v66
    v_cvt_pk_bf16_f32 v162, v116, v117
    v_exp_f32 v67, v67
    v_cvt_pk_bf16_f32 v163, v118, v119
    v_exp_f32 v68, v68
    s_waitcnt vmcnt(12)
    v_mfma_f32_32x32x16_bf16 v[80:95], a[20:23], v[168:171], 0
    v_exp_f32 v69, v69
    v_cvt_pk_bf16_f32 v164, v120, v121
    v_exp_f32 v70, v70
    v_cvt_pk_bf16_f32 v165, v122, v123
    v_exp_f32 v71, v71
    v_cvt_pk_bf16_f32 v166, v124, v125
    v_exp_f32 v72, v72
    v_cvt_pk_bf16_f32 v167, v126, v127
    v_exp_f32 v73, v73
    s_waitcnt vmcnt(9)
    v_mfma_f32_32x32x16_bf16 v[128:143], a[88:91], v[160:163], v[128:143]
    buffer_load_dwordx4 a[36:39], v3, s[8:11], s30 offen offset:1024 sc1
    v_exp_f32 v74, v74
    v_exp_f32 v75, v75
    v_exp_f32 v76, v76
    v_mfma_f32_32x32x16_bf16 v[128:143], a[92:95], v[164:167], v[128:143]
    s_mov_b64 exec, s[32:33]
    buffer_load_dwordx4 a[120:123], v6, s[8:11], s31 offen offset:3072 sc1
    buffer_load_dwordx4 a[124:127], v6, s[8:11], s31 offen offset:3584 sc1
    s_mov_b64 exec, -1
    s_add_u32 s31, s31, 4096
    v_exp_f32 v77, v77
    v_exp_f32 v78, v78
    v_exp_f32 v79, v79
    v_exp_f32 v80, v80
    v_cvt_pk_bf16_f32 v160, v64, v65
    v_exp_f32 v81, v81
    v_cvt_pk_bf16_f32 v161, v66, v67
    v_exp_f32 v82, v82
    v_cvt_pk_bf16_f32 v162, v68, v69
    v_exp_f32 v83, v83
    v_cvt_pk_bf16_f32 v163, v70, v71
    v_exp_f32 v84, v84
    s_waitcnt vmcnt(11)
    v_mfma_f32_32x32x16_bf16 v[96:111], a[24:27], v[168:171], 0
    v_exp_f32 v85, v85
    v_cvt_pk_bf16_f32 v164, v72, v73
    v_exp_f32 v86, v86
    v_cvt_pk_bf16_f32 v165, v74, v75
    v_exp_f32 v87, v87
    v_cvt_pk_bf16_f32 v166, v76, v77
    v_exp_f32 v88, v88
    v_cvt_pk_bf16_f32 v167, v78, v79
    v_exp_f32 v89, v89
    s_waitcnt vmcnt(9)
    v_mfma_f32_32x32x16_bf16 v[128:143], a[96:99], v[160:163], v[128:143]
    buffer_load_dwordx4 a[40:43], v3, s[8:11], s30 offen offset:2048 sc1
    v_exp_f32 v90, v90
    v_exp_f32 v91, v91
    v_exp_f32 v92, v92
    v_mfma_f32_32x32x16_bf16 v[128:143], a[100:103], v[164:167], v[128:143]
    s_mov_b64 exec, s[32:33]
    buffer_load_dwordx4 a[128:131], v6, s[8:11], s31 offen offset:0 sc1
    buffer_load_dwordx4 a[132:135], v6, s[8:11], s31 offen offset:512 sc1
    s_mov_b64 exec, -1
    v_exp_f32 v93, v93
    v_exp_f32 v94, v94
    v_exp_f32 v95, v95
    v_exp_f32 v96, v96
    v_cvt_pk_bf16_f32 v160, v80, v81
    v_exp_f32 v97, v97
    v_cvt_pk_bf16_f32 v161, v82, v83
    v_exp_f32 v98, v98
    v_cvt_pk_bf16_f32 v162, v84, v85
    v_exp_f32 v99, v99
    v_cvt_pk_bf16_f32 v163, v86, v87
    v_exp_f32 v100, v100
    s_waitcnt vmcnt(11)
    v_mfma_f32_32x32x16_bf16 v[112:127], a[28:31], v[168:171], 0
    v_exp_f32 v101, v101
    v_cvt_pk_bf16_f32 v164, v88, v89
    v_exp_f32 v102, v102
    v_cvt_pk_bf16_f32 v165, v90, v91
    v_exp_f32 v103, v103
    v_cvt_pk_bf16_f32 v166, v92, v93
    v_exp_f32 v104, v104
    v_cvt_pk_bf16_f32 v167, v94, v95
    v_exp_f32 v105, v105
    s_waitcnt vmcnt(9)
    v_mfma_f32_32x32x16_bf16 v[128:143], a[104:107], v[160:163], v[128:143]
    buffer_load_dwordx4 a[44:47], v3, s[8:11], s30 offen offset:3072 sc1
    s_add_u32 s30, s30, 4096
    v_exp_f32 v106, v106
    v_exp_f32 v107, v107
    v_exp_f32 v108, v108
    v_mfma_f32_32x32x16_bf16 v[128:143], a[108:111], v[164:167], v[128:143]
    s_mov_b64 exec, s[32:33]
    buffer_load_dwordx4 a[136:139], v6, s[8:11], s31 offen offset:1024 sc1
    buffer_load_dwordx4 a[140:143], v6, s[8:11], s31 offen offset:1536 sc1
    s_mov_b64 exec, -1
    v_exp_f32 v109, v109
    v_exp_f32 v110, v110
    v_exp_f32 v111, v111
    v_exp_f32 v112, v112
    v_cvt_pk_bf16_f32 v160, v96, v97
    v_exp_f32 v113, v113
    v_cvt_pk_bf16_f32 v161, v98, v99
    v_exp_f32 v114, v114
    v_cvt_pk_bf16_f32 v162, v100, v101
    v_exp_f32 v115, v115
    v_cvt_pk_bf16_f32 v163, v102, v103
    v_exp_f32 v116, v116
    s_waitcnt vmcnt(11)
    v_mfma_f32_32x32x16_bf16 v[64:79], a[32:35], v[168:171], 0
    v_exp_f32 v117, v117
    v_cvt_pk_bf16_f32 v164, v104, v105
    v_exp_f32 v118, v118
    v_cvt_pk_bf16_f32 v165, v106, v107
    v_exp_f32 v119, v119
    v_cvt_pk_bf16_f32 v166, v108, v109
    v_exp_f32 v120, v120
    v_cvt_pk_bf16_f32 v167, v110, v111
    v_exp_f32 v121, v121
    s_waitcnt vmcnt(9)
    v_mfma_f32_32x32x16_bf16 v[128:143], a[112:115], v[160:163], v[128:143]
    buffer_load_dwordx4 a[48:51], v3, s[8:11], s30 offen offset:0 sc1
    v_exp_f32 v122, v122
    v_exp_f32 v123, v123
    v_exp_f32 v124, v124
    v_mfma_f32_32x32x16_bf16 v[128:143], a[116:119], v[164:167], v[128:143]
    s_mov_b64 exec, s[32:33]
    buffer_load_dwordx4 a[144:147], v6, s[8:11], s31 offen offset:2048 sc1
    buffer_load_dwordx4 a[148:151], v6, s[8:11], s31 offen offset:2560 sc1
    s_mov_b64 exec, -1
    v_exp_f32 v125, v125
    v_exp_f32 v126, v126
    v_exp_f32 v127, v127
    v_exp_f32 v64, v64
    v_cvt_pk_bf16_f32 v160, v112, v113
    v_exp_f32 v65, v65
    v_cvt_pk_bf16_f32 v161, v114, v115
    v_exp_f32 v66, v66
    v_cvt_pk_bf16_f32 v162, v116, v117
    v_exp_f32 v67, v67
    v_cvt_pk_bf16_f32 v163, v118, v119
    v_exp_f32 v68, v68
    s_waitcnt vmcnt(11)
    v_mfma_f32_32x32x16_bf16 v[80:95], a[36:39], v[168:171], 0
    v_exp_f32 v69, v69
    v_cvt_pk_bf16_f32 v164, v120, v121
    v_exp_f32 v70, v70
    v_cvt_pk_bf16_f32 v165, v122, v123
    v_exp_f32 v71, v71
    v_cvt_pk_bf16_f32 v166, v124, v125
    v_exp_f32 v72, v72
    v_cvt_pk_bf16_f32 v167, v126, v127
    v_exp_f32 v73, v73
    s_waitcnt vmcnt(9)
    v_mfma_f32_32x32x16_bf16 v[128:143], a[120:123], v[160:163], v[128:143]
    buffer_load_dwordx4 a[52:55], v3, s[8:11], s30 offen offset:1024 sc1
    v_exp_f32 v74, v74
    v_exp_f32 v75, v75
    v_exp_f32 v76, v76
    v_mfma_f32_32x32x16_bf16 v[128:143], a[124:127], v[164:167], v[128:143]
    s_mov_b64 exec, s[32:33]
    buffer_load_dwordx4 a[152:155], v6, s[8:11], s31 offen offset:3072 sc1
    buffer_load_dwordx4 a[156:159], v6, s[8:11], s31 offen offset:3584 sc1
    s_mov_b64 exec, -1
    s_add_u32 s31, s31, 4096
    v_exp_f32 v77, v77
    v_exp_f32 v78, v78
    v_exp_f32 v79, v79
    v_exp_f32 v80, v80
    v_cvt_pk_bf16_f32 v160, v64, v65
    v_exp_f32 v81, v81
    v_cvt_pk_bf16_f32 v161, v66, v67
    v_exp_f32 v82, v82
    v_cvt_pk_bf16_f32 v162, v68, v69
    v_exp_f32 v83, v83
    v_cvt_pk_bf16_f32 v163, v70, v71
    v_exp_f32 v84, v84
    s_waitcnt vmcnt(11)
    v_mfma_f32_32x32x16_bf16 v[96:111], a[40:43], v[168:171], 0
    v_exp_f32 v85, v85
    v_cvt_pk_bf16_f32 v164, v72, v73
    v_exp_f32 v86, v86
    v_cvt_pk_bf16_f32 v165, v74, v75
    v_exp_f32 v87, v87
    v_cvt_pk_bf16_f32 v166, v76, v77
    v_exp_f32 v88, v88
    v_cvt_pk_bf16_f32 v167, v78, v79
    v_exp_f32 v89, v89
    s_waitcnt vmcnt(9)
    v_mfma_f32_32x32x16_bf16 v[128:143], a[128:131], v[160:163], v[128:143]
    buffer_load_dwordx4 a[56:59], v3, s[8:11], s30 offen offset:2048 sc1
    v_exp_f32 v90, v90
    v_exp_f32 v91, v91
    v_exp_f32 v92, v92
    v_mfma_f32_32x32x16_bf16 v[128:143], a[132:135], v[164:167], v[128:143]
    s_mov_b64 exec, s[32:33]
    buffer_load_dwordx4 a[160:163], v6, s[8:11], s31 offen offset:0 sc1
    buffer_load_dwordx4 a[164:167], v6, s[8:11], s31 offen offset:512 sc1
    s_mov_b64 exec, -1
    v_exp_f32 v93, v93
    v_exp_f32 v94, v94
    v_exp_f32 v95, v95
    v_exp_f32 v96, v96
    v_cvt_pk_bf16_f32 v160, v80, v81
    v_exp_f32 v97, v97
    v_cvt_pk_bf16_f32 v161, v82, v83
    v_exp_f32 v98, v98
    v_cvt_pk_bf16_f32 v162, v84, v85
    v_exp_f32 v99, v99
    v_cvt_pk_bf16_f32 v163, v86, v87
    v_exp_f32 v100, v100
    s_waitcnt vmcnt(11)
    v_mfma_f32_32x32x16_bf16 v[112:127], a[44:47], v[168:171], 0
    v_exp_f32 v101, v101
    v_cvt_pk_bf16_f32 v164, v88, v89
    v_exp_f32 v102, v102
    v_cvt_pk_bf16_f32 v165, v90, v91
    v_exp_f32 v103, v103
    v_cvt_pk_bf16_f32 v166, v92, v93
    v_exp_f32 v104, v104
    v_cvt_pk_bf16_f32 v167, v94, v95
    v_exp_f32 v105, v105
    s_waitcnt vmcnt(9)
    v_mfma_f32_32x32x16_bf16 v[128:143], a[136:139], v[160:163], v[128:143]
    buffer_load_dwordx4 a[60:63], v3, s[8:11], s30 offen offset:3072 sc1
    v_exp_f32 v106, v106
    v_exp_f32 v107, v107
    v_exp_f32 v108, v108
    v_mfma_f32_32x32x16_bf16 v[128:143], a[140:143], v[164:167], v[128:143]
    s_mov_b64 exec, s[32:33]
    buffer_load_dwordx4 a[168:171], v6, s[8:11], s31 offen offset:1024 sc1
    buffer_load_dwordx4 a[172:175], v6, s[8:11], s31 offen offset:1536 sc1
    s_mov_b64 exec, -1
    v_exp_f32 v109, v109
    v_exp_f32 v110, v110
    v_exp_f32 v111, v111
    v_exp_f32 v112, v112
    v_cvt_pk_bf16_f32 v160, v96, v97
    v_exp_f32 v113, v113
    v_cvt_pk_bf16_f32 v161, v98, v99
    v_exp_f32 v114, v114
    v_cvt_pk_bf16_f32 v162, v100, v101
    v_exp_f32 v115, v115
    v_cvt_pk_bf16_f32 v163, v102, v103
    v_exp_f32 v116, v116
    s_waitcnt vmcnt(11)
    v_mfma_f32_32x32x16_bf16 v[64:79], a[48:51], v[168:171], 0
    v_exp_f32 v117, v117
    v_cvt_pk_bf16_f32 v164, v104, v105
    v_exp_f32 v118, v118
    v_cvt_pk_bf16_f32 v165, v106, v107
    v_exp_f32 v119, v119
    v_cvt_pk_bf16_f32 v166, v108, v109
    v_exp_f32 v120, v120
    v_cvt_pk_bf16_f32 v167, v110, v111
    v_exp_f32 v121, v121
    s_waitcnt vmcnt(9)
    v_mfma_f32_32x32x16_bf16 v[128:143], a[144:147], v[160:163], v[128:143]
    buffer_load_dwordx4 v[20:23], v3, s[8:11], s46 offen sc1
    v_exp_f32 v122, v122
    v_exp_f32 v123, v123
    v_exp_f32 v124, v124
    v_mfma_f32_32x32x16_bf16 v[128:143], a[148:151], v[164:167], v[128:143]
    s_mov_b64 exec, s[32:33]
    buffer_load_dwordx4 a[176:179], v6, s[8:11], s31 offen offset:2048 sc1
    buffer_load_dwordx4 a[180:183], v6, s[8:11], s31 offen offset:2560 sc1
    s_mov_b64 exec, -1
    v_exp_f32 v125, v125
    v_exp_f32 v126, v126
    v_exp_f32 v127, v127
    v_exp_f32 v64, v64
    v_cvt_pk_bf16_f32 v160, v112, v113
    v_exp_f32 v65, v65
    v_cvt_pk_bf16_f32 v161, v114, v115
    v_exp_f32 v66, v66
    v_cvt_pk_bf16_f32 v162, v116, v117
    v_exp_f32 v67, v67
    v_cvt_pk_bf16_f32 v163, v118, v119
    v_exp_f32 v68, v68
    s_waitcnt vmcnt(11)
    v_mfma_f32_32x32x16_bf16 v[80:95], a[52:55], v[168:171], 0
    v_exp_f32 v69, v69
    v_cvt_pk_bf16_f32 v164, v120, v121
    v_exp_f32 v70, v70
    v_cvt_pk_bf16_f32 v165, v122, v123
    v_exp_f32 v71, v71
    v_cvt_pk_bf16_f32 v166, v124, v125
    v_exp_f32 v72, v72
    v_cvt_pk_bf16_f32 v167, v126, v127
    v_exp_f32 v73, v73
    s_waitcnt vmcnt(9)
    v_mfma_f32_32x32x16_bf16 v[128:143], a[152:155], v[160:163], v[128:143]
    v_exp_f32 v74, v74
    v_exp_f32 v75, v75
    v_exp_f32 v76, v76
    v_mfma_f32_32x32x16_bf16 v[128:143], a[156:159], v[164:167], v[128:143]
    s_mov_b64 exec, s[32:33]
    buffer_load_dwordx4 a[184:187], v6, s[8:11], s31 offen offset:3072 sc1
    buffer_load_dwordx4 a[188:191], v6, s[8:11], s31 offen offset:3584 sc1
    s_mov_b64 exec, -1
    v_exp_f32 v77, v77
    v_exp_f32 v78, v78
    v_exp_f32 v79, v79
    v_exp_f32 v80, v80
    v_cvt_pk_bf16_f32 v160, v64, v65
    v_exp_f32 v81, v81
    v_cvt_pk_bf16_f32 v161, v66, v67
    v_exp_f32 v82, v82
    v_cvt_pk_bf16_f32 v162, v68, v69
    v_exp_f32 v83, v83
    v_cvt_pk_bf16_f32 v163, v70, v71
    v_exp_f32 v84, v84
    s_waitcnt vmcnt(10)
    v_mfma_f32_32x32x16_bf16 v[96:111], a[56:59], v[168:171], 0
    v_exp_f32 v85, v85
    v_cvt_pk_bf16_f32 v164, v72, v73
    v_exp_f32 v86, v86
    v_cvt_pk_bf16_f32 v165, v74, v75
    v_exp_f32 v87, v87
    v_cvt_pk_bf16_f32 v166, v76, v77
    v_exp_f32 v88, v88
    v_cvt_pk_bf16_f32 v167, v78, v79
    v_exp_f32 v89, v89
    s_waitcnt vmcnt(8)
    v_mfma_f32_32x32x16_bf16 v[128:143], a[160:163], v[160:163], v[128:143]
    v_exp_f32 v90, v90
    v_exp_f32 v91, v91
    v_exp_f32 v92, v92
    v_mfma_f32_32x32x16_bf16 v[128:143], a[164:167], v[164:167], v[128:143]
    v_exp_f32 v93, v93
    v_exp_f32 v94, v94
    v_exp_f32 v95, v95
    v_exp_f32 v96, v96
    v_cvt_pk_bf16_f32 v160, v80, v81
    v_exp_f32 v97, v97
    v_cvt_pk_bf16_f32 v161, v82, v83
    v_exp_f32 v98, v98
    v_cvt_pk_bf16_f32 v162, v84, v85
    v_exp_f32 v99, v99
    v_cvt_pk_bf16_f32 v163, v86, v87
    v_exp_f32 v100, v100
    s_waitcnt vmcnt(7)
    v_mfma_f32_32x32x16_bf16 v[112:127], a[60:63], v[168:171], 0
    v_exp_f32 v101, v101
    v_cvt_pk_bf16_f32 v164, v88, v89
    v_exp_f32 v102, v102
    v_cvt_pk_bf16_f32 v165, v90, v91
    v_exp_f32 v103, v103
    v_cvt_pk_bf16_f32 v166, v92, v93
    v_exp_f32 v104, v104
    v_cvt_pk_bf16_f32 v167, v94, v95
    v_exp_f32 v105, v105
    s_waitcnt vmcnt(5)
    v_mfma_f32_32x32x16_bf16 v[128:143], a[168:171], v[160:163], v[128:143]
    v_exp_f32 v106, v106
    v_exp_f32 v107, v107
    v_exp_f32 v108, v108
    v_mfma_f32_32x32x16_bf16 v[128:143], a[172:175], v[164:167], v[128:143]
    v_exp_f32 v109, v109
    v_exp_f32 v110, v110
    v_exp_f32 v111, v111
    v_exp_f32 v112, v112
    v_cvt_pk_bf16_f32 v160, v96, v97
    v_exp_f32 v113, v113
    v_cvt_pk_bf16_f32 v161, v98, v99
    v_exp_f32 v114, v114
    v_cvt_pk_bf16_f32 v162, v100, v101
    v_exp_f32 v115, v115
    v_cvt_pk_bf16_f32 v163, v102, v103
    v_exp_f32 v116, v116
    v_mfma_f32_32x32x16_bf16 v[64:79], a[0:3], v[172:175], 0
    v_exp_f32 v117, v117
    v_cvt_pk_bf16_f32 v164, v104, v105
    v_exp_f32 v118, v118
    v_cvt_pk_bf16_f32 v165, v106, v107
    v_exp_f32 v119, v119
    v_cvt_pk_bf16_f32 v166, v108, v109
    v_exp_f32 v120, v120
    v_cvt_pk_bf16_f32 v167, v110, v111
    v_exp_f32 v121, v121
    s_waitcnt vmcnt(2)
    v_mfma_f32_32x32x16_bf16 v[128:143], a[176:179], v[160:163], v[128:143]
    v_exp_f32 v122, v122
    v_exp_f32 v123, v123
    v_exp_f32 v124, v124
    v_mfma_f32_32x32x16_bf16 v[128:143], a[180:183], v[164:167], v[128:143]
    v_exp_f32 v125, v125
    v_exp_f32 v126, v126
    v_exp_f32 v127, v127
    v_exp_f32 v64, v64
    v_cvt_pk_bf16_f32 v160, v112, v113
    v_exp_f32 v65, v65
    v_cvt_pk_bf16_f32 v161, v114, v115
    v_exp_f32 v66, v66
    v_cvt_pk_bf16_f32 v162, v116, v117
    v_exp_f32 v67, v67
    v_cvt_pk_bf16_f32 v163, v118, v119
    v_exp_f32 v68, v68
    v_mfma_f32_32x32x16_bf16 v[80:95], a[4:7], v[172:175], 0
    buffer_load_dwordx4 v[168:171], v3, s[8:11], s28 offen sc1
    s_add_u32 s28, s28, 1024
    v_exp_f32 v69, v69
    v_cvt_pk_bf16_f32 v164, v120, v121
    v_exp_f32 v70, v70
    v_cvt_pk_bf16_f32 v165, v122, v123
    v_exp_f32 v71, v71
    v_cvt_pk_bf16_f32 v166, v124, v125
    v_exp_f32 v72, v72
    v_cvt_pk_bf16_f32 v167, v126, v127
    v_exp_f32 v73, v73
    s_waitcnt vmcnt(1)
    v_mfma_f32_32x32x16_bf16 v[128:143], a[184:187], v[160:163], v[128:143]
    v_exp_f32 v74, v74
    v_exp_f32 v75, v75
    v_exp_f32 v76, v76
    v_mfma_f32_32x32x16_bf16 v[128:143], a[188:191], v[164:167], v[128:143]
    v_exp_f32 v77, v77
    v_exp_f32 v78, v78
    v_exp_f32 v79, v79
    v_exp_f32 v80, v80
    v_cvt_pk_bf16_f32 v160, v64, v65
    v_exp_f32 v81, v81
    v_cvt_pk_bf16_f32 v161, v66, v67
    v_exp_f32 v82, v82
    v_cvt_pk_bf16_f32 v162, v68, v69
    v_exp_f32 v83, v83
    v_cvt_pk_bf16_f32 v163, v70, v71
    v_exp_f32 v84, v84
    v_mfma_f32_32x32x16_bf16 v[96:111], a[8:11], v[172:175], 0
    v_exp_f32 v85, v85
    v_cvt_pk_bf16_f32 v164, v72, v73
    v_exp_f32 v86, v86
    v_cvt_pk_bf16_f32 v165, v74, v75
    v_exp_f32 v87, v87
    v_cvt_pk_bf16_f32 v166, v76, v77
    v_exp_f32 v88, v88
    v_cvt_pk_bf16_f32 v167, v78, v79
    v_exp_f32 v89, v89
    v_mfma_f32_32x32x16_bf16 v[144:159], a[64:67], v[160:163], 0
    ds_write_b128 v8, v[128:131] offset:9216
    ds_write_b128 v8, v[132:135] offset:10240
    ds_write_b32 v9, v136 offset:11264
    v_exp_f32 v90, v90
    v_exp_f32 v91, v91
    v_exp_f32 v92, v92
    v_mfma_f32_32x32x16_bf16 v[144:159], a[68:71], v[164:167], v[144:159]
    v_exp_f32 v93, v93
    v_exp_f32 v94, v94
    v_exp_f32 v95, v95
    v_exp_f32 v96, v96
    v_cvt_pk_bf16_f32 v160, v80, v81
    v_exp_f32 v97, v97
    v_cvt_pk_bf16_f32 v161, v82, v83
    v_exp_f32 v98, v98
    v_cvt_pk_bf16_f32 v162, v84, v85
    v_exp_f32 v99, v99
    v_cvt_pk_bf16_f32 v163, v86, v87
    v_exp_f32 v100, v100
    v_mfma_f32_32x32x16_bf16 v[112:127], a[12:15], v[172:175], 0
    s_mov_b32 s62, 20000
mg_PB11:
    v_xor_b32 v20, s6, v20
    v_xor_b32 v21, s6, v21
    v_xor_b32 v22, s6, v22
    v_xor_b32 v23, s6, v23
    v_or3_b32 v20, v20, v21, v22
    v_or_b32 v20, v20, v23
    v_cmp_ne_u32 vcc, 0, v20
    s_nop 3
    s_cbranch_vccz mg_PBD12
    buffer_load_dwordx4 v[20:23], v3, s[8:11], s46 offen sc1
    s_waitcnt vmcnt(0)
    s_sub_u32 s62, s62, 1
    s_cmp_lg_u32 s62, 0
    s_cbranch_scc1 mg_PB11
mg_PBD12:
    v_exp_f32 v101, v101
    v_cvt_pk_bf16_f32 v164, v88, v89
    v_exp_f32 v102, v102
    v_cvt_pk_bf16_f32 v165, v90, v91
    v_exp_f32 v103, v103
    v_cvt_pk_bf16_f32 v166, v92, v93
    v_exp_f32 v104, v104
    v_cvt_pk_bf16_f32 v167, v94, v95
    v_exp_f32 v105, v105
    v_mfma_f32_32x32x16_bf16 v[144:159], a[72:75], v[160:163], v[144:159]
    v_exp_f32 v106, v106
    v_exp_f32 v107, v107
    v_exp_f32 v108, v108
    v_mfma_f32_32x32x16_bf16 v[144:159], a[76:79], v[164:167], v[144:159]
    v_exp_f32 v109, v109
    v_exp_f32 v110, v110
    v_exp_f32 v111, v111
    v_exp_f32 v112, v112
    v_cvt_pk_bf16_f32 v160, v96, v97
    v_exp_f32 v113, v113
    v_cvt_pk_bf16_f32 v161, v98, v99
    v_exp_f32 v114, v114
    v_cvt_pk_bf16_f32 v162, v100, v101
    v_exp_f32 v115, v115
    v_cvt_pk_bf16_f32 v163, v102, v103
    v_exp_f32 v116, v116
    v_mfma_f32_32x32x16_bf16 v[64:79], a[16:19], v[172:175], 0
    v_exp_f32 v117, v117
    v_cvt_pk_bf16_f32 v164, v104, v105
    v_exp_f32 v118, v118
    v_cvt_pk_bf16_f32 v165, v106, v107
    v_exp_f32 v119, v119
    v_cvt_pk_bf16_f32 v166, v108, v109
    v_exp_f32 v120, v120
    v_cvt_pk_bf16_f32 v167, v110, v111
    v_exp_f32 v121, v121
    v_mfma_f32_32x32x16_bf16 v[144:159], a[80:83], v[160:163], v[144:159]
    buffer_load_dwordx4 a[192:195], v3, s[8:11], s40 offen offset:0 sc1
    buffer_load_dwordx4 a[196:199], v3, s[8:11], s41 offen offset:0 sc1
    v_exp_f32 v122, v122
    v_exp_f32 v123, v123
    v_exp_f32 v124, v124
    v_mfma_f32_32x32x16_bf16 v[144:159], a[84:87], v[164:167], v[144:159]
    buffer_load_dwordx4 a[200:203], v3, s[8:11], s40 offen offset:1024 sc1
    buffer_load_dwordx4 a[204:207], v3, s[8:11], s41 offen offset:1024 sc1
    v_exp_f32 v125, v125
    v_exp_f32 v126, v126
    v_exp_f32 v127, v127
    v_exp_f32 v64, v64
    v_cvt_pk_bf16_f32 v160, v112, v113
    v_exp_f32 v65, v65
    v_cvt_pk_bf16_f32 v161, v114, v115
    v_exp_f32 v66, v66
    v_cvt_pk_bf16_f32 v162, v116, v117
    v_exp_f32 v67, v67
    v_cvt_pk_bf16_f32 v163, v118, v119
    v_exp_f32 v68, v68
    v_mfma_f32_32x32x16_bf16 v[80:95], a[20:23], v[172:175], 0
    v_exp_f32 v69, v69
    v_cvt_pk_bf16_f32 v164, v120, v121
    v_exp_f32 v70, v70
    v_cvt_pk_bf16_f32 v165, v122, v123
    v_exp_f32 v71, v71
    v_cvt_pk_bf16_f32 v166, v124, v125
    v_exp_f32 v72, v72
    v_cvt_pk_bf16_f32 v167, v126, v127
    v_exp_f32 v73, v73
    v_mfma_f32_32x32x16_bf16 v[144:159], a[88:91], v[160:163], v[144:159]
    buffer_load_dwordx4 a[208:211], v3, s[8:11], s40 offen offset:2048 sc1
    buffer_load_dwordx4 a[212:215], v3, s[8:11], s41 offen offset:2048 sc1
    v_exp_f32 v74, v74
    v_exp_f32 v75, v75
    v_exp_f32 v76, v76
    v_mfma_f32_32x32x16_bf16 v[144:159], a[92:95], v[164:167], v[144:159]
    buffer_load_dwordx4 a[216:219], v3, s[8:11], s40 offen offset:3072 sc1
    buffer_load_dwordx4 a[220:223], v3, s[8:11], s41 offen offset:3072 sc1
    v_exp_f32 v77, v77
    v_exp_f32 v78, v78
    v_exp_f32 v79, v79
    v_exp_f32 v80, v80
    v_cvt_pk_bf16_f32 v160, v64, v65
    v_exp_f32 v81, v81
    v_cvt_pk_bf16_f32 v161, v66, v67
    v_exp_f32 v82, v82
    v_cvt_pk_bf16_f32 v162, v68, v69
    v_exp_f32 v83, v83
    v_cvt_pk_bf16_f32 v163, v70, v71
    v_exp_f32 v84, v84
    v_mfma_f32_32x32x16_bf16 v[96:111], a[24:27], v[172:175], 0
    v_exp_f32 v85, v85
    v_cvt_pk_bf16_f32 v164, v72, v73
    v_exp_f32 v86, v86
    v_cvt_pk_bf16_f32 v165, v74, v75
    v_exp_f32 v87, v87
    v_cvt_pk_bf16_f32 v166, v76, v77
    v_exp_f32 v88, v88
    v_cvt_pk_bf16_f32 v167, v78, v79
    v_exp_f32 v89, v89
    v_mfma_f32_32x32x16_bf16 v[144:159], a[96:99], v[160:163], v[144:159]
    s_add_u32 s40, s40, 4096
    s_add_u32 s41, s41, 4096
    v_exp_f32 v90, v90
    v_exp_f32 v91, v91
    v_exp_f32 v92, v92
    v_mfma_f32_32x32x16_bf16 v[144:159], a[100:103], v[164:167], v[144:159]
    buffer_load_dwordx4 a[224:227], v3, s[8:11], s40 offen offset:0 sc1
    buffer_load_dwordx4 a[228:231], v3, s[8:11], s41 offen offset:0 sc1
    v_exp_f32 v93, v93
    v_exp_f32 v94, v94
    v_exp_f32 v95, v95
    v_exp_f32 v96, v96
    v_cvt_pk_bf16_f32 v160, v80, v81
    v_exp_f32 v97, v97
    v_cvt_pk_bf16_f32 v161, v82, v83
    v_exp_f32 v98, v98
    v_cvt_pk_bf16_f32 v162, v84, v85
    v_exp_f32 v99, v99
    v_cvt_pk_bf16_f32 v163, v86, v87
    v_exp_f32 v100, v100
    v_mfma_f32_32x32x16_bf16 v[112:127], a[28:31], v[172:175], 0
    v_exp_f32 v101, v101
    v_cvt_pk_bf16_f32 v164, v88, v89
    v_exp_f32 v102, v102
    v_cvt_pk_bf16_f32 v165, v90, v91
    v_exp_f32 v103, v103
    v_cvt_pk_bf16_f32 v166, v92, v93
    v_exp_f32 v104, v104
    v_cvt_pk_bf16_f32 v167, v94, v95
    v_exp_f32 v105, v105
    v_mfma_f32_32x32x16_bf16 v[144:159], a[104:107], v[160:163], v[144:159]
    buffer_load_dwordx4 a[232:235], v3, s[8:11], s40 offen offset:1024 sc1
    buffer_load_dwordx4 a[236:239], v3, s[8:11], s41 offen offset:1024 sc1
    v_exp_f32 v106, v106
    v_exp_f32 v107, v107
    v_exp_f32 v108, v108
    v_mfma_f32_32x32x16_bf16 v[144:159], a[108:111], v[164:167], v[144:159]
    buffer_load_dwordx4 a[240:243], v3, s[8:11], s40 offen offset:2048 sc1
    buffer_load_dwordx4 a[244:247], v3, s[8:11], s41 offen offset:2048 sc1
    v_exp_f32 v109, v109
    v_exp_f32 v110, v110
    v_exp_f32 v111, v111
    v_exp_f32 v112, v112
    v_cvt_pk_bf16_f32 v160, v96, v97
    v_exp_f32 v113, v113
    v_cvt_pk_bf16_f32 v161, v98, v99
    v_exp_f32 v114, v114
    v_cvt_pk_bf16_f32 v162, v100, v101
    v_exp_f32 v115, v115
    v_cvt_pk_bf16_f32 v163, v102, v103
    v_exp_f32 v116, v116
    v_mfma_f32_32x32x16_bf16 v[64:79], a[32:35], v[172:175], 0
    v_exp_f32 v117, v117
    v_cvt_pk_bf16_f32 v164, v104, v105
    v_exp_f32 v118, v118
    v_cvt_pk_bf16_f32 v165, v106, v107
    v_exp_f32 v119, v119
    v_cvt_pk_bf16_f32 v166, v108, v109
    v_exp_f32 v120, v120
    v_cvt_pk_bf16_f32 v167, v110, v111
    v_exp_f32 v121, v121
    v_mfma_f32_32x32x16_bf16 v[144:159], a[112:115], v[160:163], v[144:159]
    buffer_load_dwordx4 a[248:251], v3, s[8:11], s40 offen offset:3072 sc1
    buffer_load_dwordx4 a[252:255], v3, s[8:11], s41 offen offset:3072 sc1
    v_exp_f32 v122, v122
    v_exp_f32 v123, v123
    v_exp_f32 v124, v124
    v_mfma_f32_32x32x16_bf16 v[144:159], a[116:119], v[164:167], v[144:159]
    s_add_u32 m0, s45, 98304
    s_nop 0
    buffer_load_dwordx4 v3, s[8:11], s44 offen offset:0 sc1 lds
    v_exp_f32 v125, v125
    v_exp_f32 v126, v126
    v_exp_f32 v127, v127
    v_exp_f32 v64, v64
    v_cvt_pk_bf16_f32 v160, v112, v113
    v_exp_f32 v65, v65
    v_cvt_pk_bf16_f32 v161, v114, v115
    v_exp_f32 v66, v66
    v_cvt_pk_bf16_f32 v162, v116, v117
    v_exp_f32 v67, v67
    v_cvt_pk_bf16_f32 v163, v118, v119
    v_exp_f32 v68, v68
    v_mfma_f32_32x32x16_bf16 v[80:95], a[36:39], v[172:175], 0
    v_exp_f32 v69, v69
    v_cvt_pk_bf16_f32 v164, v120, v121
    v_exp_f32 v70, v70
    v_cvt_pk_bf16_f32 v165, v122, v123
    v_exp_f32 v71, v71
    v_cvt_pk_bf16_f32 v166, v124, v125
    v_exp_f32 v72, v72
    v_cvt_pk_bf16_f32 v167, v126, v127
    v_exp_f32 v73, v73
    v_mfma_f32_32x32x16_bf16 v[144:159], a[120:123], v[160:163], v[144:159]
    buffer_load_dwordx4 v3, s[8:11], s44 offen offset:1024 sc1 lds
    buffer_load_dwordx4 v3, s[8:11], s44 offen offset:2048 sc1 lds
    v_exp_f32 v74, v74
    v_exp_f32 v75, v75
    v_exp_f32 v76, v76
    v_mfma_f32_32x32x16_bf16 v[144:159], a[124:127], v[164:167], v[144:159]
    buffer_load_dwordx4 v3, s[8:11], s44 offen offset:3072 sc1 lds
    s_add_u32 s44, s44, 16384
    v_exp_f32 v77, v77
    v_exp_f32 v78, v78
    v_exp_f32 v79, v79
    v_exp_f32 v80, v80
    v_cvt_pk_bf16_f32 v160, v64, v65
    v_exp_f32 v81, v81
    v_cvt_pk_bf16_f32 v161, v66, v67
    v_exp_f32 v82, v82
    v_cvt_pk_bf16_f32 v162, v68, v69
    v_exp_f32 v83, v83
    v_cvt_pk_bf16_f32 v163, v70, v71
    v_exp_f32 v84, v84
    v_mfma_f32_32x32x16_bf16 v[96:111], a[40:43], v[172:175], 0
    v_exp_f32 v85, v85
    v_cvt_pk_bf16_f32 v164, v72, v73
    v_exp_f32 v86, v86
    v_cvt_pk_bf16_f32 v165, v74, v75
    v_exp_f32 v87, v87
    v_cvt_pk_bf16_f32 v166, v76, v77
    v_exp_f32 v88, v88
    v_cvt_pk_bf16_f32 v167, v78, v79
    v_exp_f32 v89, v89
    v_mfma_f32_32x32x16_bf16 v[144:159], a[128:131], v[160:163], v[144:159]
    s_add_u32 m0, s45, 114688
    s_nop 0
    buffer_load_dwordx4 v3, s[8:11], s44 offen offset:0 sc1 lds
    v_exp_f32 v90, v90
    v_exp_f32 v91, v91
    v_exp_f32 v92, v92
    v_mfma_f32_32x32x16_bf16 v[144:159], a[132:135], v[164:167], v[144:159]
    buffer_load_dwordx4 v3, s[8:11], s44 offen offset:1024 sc1 lds
    buffer_load_dwordx4 v3, s[8:11], s44 offen offset:2048 sc1 lds
    v_exp_f32 v93, v93
    v_exp_f32 v94, v94
    v_exp_f32 v95, v95
    v_exp_f32 v96, v96
    v_cvt_pk_bf16_f32 v160, v80, v81
    v_exp_f32 v97, v97
    v_cvt_pk_bf16_f32 v161, v82, v83
    v_exp_f32 v98, v98
    v_cvt_pk_bf16_f32 v162, v84, v85
    v_exp_f32 v99, v99
    v_cvt_pk_bf16_f32 v163, v86, v87
    v_exp_f32 v100, v100
    v_mfma_f32_32x32x16_bf16 v[112:127], a[44:47], v[172:175], 0
    v_exp_f32 v101, v101
    v_cvt_pk_bf16_f32 v164, v88, v89
    v_exp_f32 v102, v102
    v_cvt_pk_bf16_f32 v165, v90, v91
    v_exp_f32 v103, v103
    v_cvt_pk_bf16_f32 v166, v92, v93
    v_exp_f32 v104, v104
    v_cvt_pk_bf16_f32 v167, v94, v95
    v_exp_f32 v105, v105
    v_mfma_f32_32x32x16_bf16 v[144:159], a[136:139], v[160:163], v[144:159]
    buffer_load_dwordx4 v3, s[8:11], s44 offen offset:3072 sc1 lds
    s_add_u32 s44, s44, 16384
    v_exp_f32 v106, v106
    v_exp_f32 v107, v107
    v_exp_f32 v108, v108
    v_mfma_f32_32x32x16_bf16 v[144:159], a[140:143], v[164:167], v[144:159]
    s_add_u32 m0, s45, 131072
    s_nop 0
    buffer_load_dwordx4 v3, s[8:11], s44 offen offset:0 sc1 lds
    v_exp_f32 v109, v109
    v_exp_f32 v110, v110
    v_exp_f32 v111, v111
    v_exp_f32 v112, v112
    v_cvt_pk_bf16_f32 v160, v96, v97
    v_exp_f32 v113, v113
    v_cvt_pk_bf16_f32 v161, v98, v99
    v_exp_f32 v114, v114
    v_cvt_pk_bf16_f32 v162, v100, v101
    v_exp_f32 v115, v115
    v_cvt_pk_bf16_f32 v163, v102, v103
    v_exp_f32 v116, v116
    v_mfma_f32_32x32x16_bf16 v[64:79], a[48:51], v[172:175], 0
    v_exp_f32 v117, v117
    v_cvt_pk_bf16_f32 v164, v104, v105
    v_exp_f32 v118, v118
    v_cvt_pk_bf16_f32 v165, v106, v107
    v_exp_f32 v119, v119
    v_cvt_pk_bf16_f32 v166, v108, v109
    v_exp_f32 v120, v120
    v_cvt_pk_bf16_f32 v167, v110, v111
    v_exp_f32 v121, v121
    v_mfma_f32_32x32x16_bf16 v[144:159], a[144:147], v[160:163], v[144:159]
    buffer_load_dwordx4 v3, s[8:11], s44 offen offset:1024 sc1 lds
    buffer_load_dwordx4 v3, s[8:11], s44 offen offset:2048 sc1 lds
    v_exp_f32 v122, v122
    v_exp_f32 v123, v123
    v_exp_f32 v124, v124
    v_mfma_f32_32x32x16_bf16 v[144:159], a[148:151], v[164:167], v[144:159]
    buffer_load_dwordx4 v3, s[8:11], s44 offen offset:3072 sc1 lds
    s_add_u32 s44, s44, 16384
    v_exp_f32 v125, v125
    v_exp_f32 v126, v126
    v_exp_f32 v127, v127
    v_exp_f32 v64, v64
    v_cvt_pk_bf16_f32 v160, v112, v113
    v_exp_f32 v65, v65
    v_cvt_pk_bf16_f32 v161, v114, v115
    v_exp_f32 v66, v66
    v_cvt_pk_bf16_f32 v162, v116, v117
    v_exp_f32 v67, v67
    v_cvt_pk_bf16_f32 v163, v118, v119
    v_exp_f32 v68, v68
    v_mfma_f32_32x32x16_bf16 v[80:95], a[52:55], v[172:175], 0
    v_exp_f32 v69, v69
    v_cvt_pk_bf16_f32 v164, v120, v121
    v_exp_f32 v70, v70
    v_cvt_pk_bf16_f32 v165, v122, v123
    v_exp_f32 v71, v71
    v_cvt_pk_bf16_f32 v166, v124, v125
    v_exp_f32 v72, v72
    v_cvt_pk_bf16_f32 v167, v126, v127
    v_exp_f32 v73, v73
    v_mfma_f32_32x32x16_bf16 v[144:159], a[152:155], v[160:163], v[144:159]
    s_add_u32 m0, s45, 147456
    s_nop 0
    buffer_load_dwordx4 v3, s[8:11], s44 offen offset:0 sc1 lds
    v_exp_f32 v74, v74
    v_exp_f32 v75, v75
    v_exp_f32 v76, v76
    v_mfma_f32_32x32x16_bf16 v[144:159], a[156:159], v[164:167], v[144:159]
    buffer_load_dwordx4 v3, s[8:11], s44 offen offset:1024 sc1 lds
    buffer_load_dwordx4 v3, s[8:11], s44 offen offset:2048 sc1 lds
    v_exp_f32 v77, v77
    v_exp_f32 v78, v78
    v_exp_f32 v79, v79
    v_exp_f32 v80, v80
    v_cvt_pk_bf16_f32 v160, v64, v65
    v_exp_f32 v81, v81
    v_cvt_pk_bf16_f32 v161, v66, v67
    v_exp_f32 v82, v82
    v_cvt_pk_bf16_f32 v162, v68, v69
    v_exp_f32 v83, v83
    v_cvt_pk_bf16_f32 v163, v70, v71
    v_exp_f32 v84, v84
    v_mfma_f32_32x32x16_bf16 v[96:111], a[56:59], v[172:175], 0
    v_exp_f32 v85, v85
    v_cvt_pk_bf16_f32 v164, v72, v73
    v_exp_f32 v86, v86
    v_cvt_pk_bf16_f32 v165, v74, v75
    v_exp_f32 v87, v87
    v_cvt_pk_bf16_f32 v166, v76, v77
    v_exp_f32 v88, v88
    v_cvt_pk_bf16_f32 v167, v78, v79
    v_exp_f32 v89, v89
    v_mfma_f32_32x32x16_bf16 v[144:159], a[160:163], v[160:163], v[144:159]
    buffer_load_dwordx4 v3, s[8:11], s44 offen offset:3072 sc1 lds
    s_add_u32 s44, s44, 16384
    v_exp_f32 v90, v90
    v_exp_f32 v91, v91
    v_exp_f32 v92, v92
    v_mfma_f32_32x32x16_bf16 v[144:159], a[164:167], v[164:167], v[144:159]
    v_exp_f32 v93, v93
    v_exp_f32 v94, v94
    v_exp_f32 v95, v95
    v_exp_f32 v96, v96
    v_cvt_pk_bf16_f32 v160, v80, v81
    v_exp_f32 v97, v97
    v_cvt_pk_bf16_f32 v161, v82, v83
    v_exp_f32 v98, v98
    v_cvt_pk_bf16_f32 v162, v84, v85
    v_exp_f32 v99, v99
    v_cvt_pk_bf16_f32 v163, v86, v87
    v_exp_f32 v100, v100
    v_mfma_f32_32x32x16_bf16 v[112:127], a[60:63], v[172:175], 0
    v_exp_f32 v101, v101
    v_cvt_pk_bf16_f32 v164, v88, v89
    v_exp_f32 v102, v102
    v_cvt_pk_bf16_f32 v165, v90, v91
    v_exp_f32 v103, v103
    v_cvt_pk_bf16_f32 v166, v92, v93
    v_exp_f32 v104, v104
    v_cvt_pk_bf16_f32 v167, v94, v95
    v_exp_f32 v105, v105
    v_mfma_f32_32x32x16_bf16 v[144:159], a[168:171], v[160:163], v[144:159]
    v_exp_f32 v106, v106
    v_exp_f32 v107, v107
    v_exp_f32 v108, v108
    v_mfma_f32_32x32x16_bf16 v[144:159], a[172:175], v[164:167], v[144:159]
    v_exp_f32 v109, v109
    v_exp_f32 v110, v110
    v_exp_f32 v111, v111
    v_exp_f32 v112, v112
    v_cvt_pk_bf16_f32 v160, v96, v97
    v_exp_f32 v113, v113
    v_cvt_pk_bf16_f32 v161, v98, v99
    v_exp_f32 v114, v114
    v_cvt_pk_bf16_f32 v162, v100, v101
    v_exp_f32 v115, v115
    v_cvt_pk_bf16_f32 v163, v102, v103
    v_exp_f32 v116, v116
    s_waitcnt vmcnt(32)
    v_mfma_f32_32x32x16_bf16 v[64:79], a[0:3], v[168:171], 0
    v_exp_f32 v117, v117
    v_cvt_pk_bf16_f32 v164, v104, v105
    v_exp_f32 v118, v118
    v_cvt_pk_bf16_f32 v165, v106, v107
    v_exp_f32 v119, v119
    v_cvt_pk_bf16_f32 v166, v108, v109
    v_exp_f32 v120, v120
    v_cvt_pk_bf16_f32 v167, v110, v111
    v_exp_f32 v121, v121
    v_mfma_f32_32x32x16_bf16 v[144:159], a[176:179], v[160:163], v[144:159]
    v_exp_f32 v122, v122
    v_exp_f32 v123, v123
    v_exp_f32 v124, v124
    v_mfma_f32_32x32x16_bf16 v[144:159], a[180:183], v[164:167], v[144:159]
    v_exp_f32 v125, v125
    v_exp_f32 v126, v126
    v_exp_f32 v127, v127
    v_add_u32 v8, 18432, v8
    v_add_u32 v9, 18432, v9
    s_mov_b32 s35, 3
mg_ATT:
    v_exp_f32 v64, v64
    v_cvt_pk_bf16_f32 v160, v112, v113
    v_exp_f32 v65, v65
    v_cvt_pk_bf16_f32 v161, v114, v115
    v_exp_f32 v66, v66
    v_cvt_pk_bf16_f32 v162, v116, v117
    v_exp_f32 v67, v67
    v_cvt_pk_bf16_f32 v163, v118, v119
    v_exp_f32 v68, v68
    v_mfma_f32_32x32x16_bf16 v[80:95], a[4:7], v[168:171], 0
    buffer_load_dwordx4 v[172:175], v3, s[8:11], s28 offen sc1
    s_add_u32 s28, s28, 1024
    s_min_u32 s28, s28, s50
    v_exp_f32 v69, v69
    v_cvt_pk_bf16_f32 v164, v120, v121
    v_exp_f32 v70, v70
    v_cvt_pk_bf16_f32 v165, v122, v123
    v_exp_f32 v71, v71
    v_cvt_pk_bf16_f32 v166, v124, v125
    v_exp_f32 v72, v72
    v_cvt_pk_bf16_f32 v167, v126, v127
    v_exp_f32 v73, v73
    v_mfma_f32_32x32x16_bf16 v[144:159], a[184:187], v[160:163], v[144:159]
    v_exp_f32 v74, v74
    v_exp_f32 v75, v75
    v_exp_f32 v76, v76
    v_mfma_f32_32x32x16_bf16 v[144:159], a[188:191], v[164:167], v[144:159]
    v_exp_f32 v77, v77
    v_exp_f32 v78, v78
    v_exp_f32 v79, v79
    v_exp_f32 v80, v80
    v_cvt_pk_bf16_f32 v160, v64, v65
    v_exp_f32 v81, v81
    v_cvt_pk_bf16_f32 v161, v66, v67
    v_exp_f32 v82, v82
    v_cvt_pk_bf16_f32 v162, v68, v69
    v_exp_f32 v83, v83
    v_cvt_pk_bf16_f32 v163, v70, v71
    v_exp_f32 v84, v84
    v_mfma_f32_32x32x16_bf16 v[96:111], a[8:11], v[168:171], 0
    v_exp_f32 v85, v85
    v_cvt_pk_bf16_f32 v164, v72, v73
    v_exp_f32 v86, v86
    v_cvt_pk_bf16_f32 v165, v74, v75
    v_exp_f32 v87, v87
    v_cvt_pk_bf16_f32 v166, v76, v77
    v_exp_f32 v88, v88
    v_cvt_pk_bf16_f32 v167, v78, v79
    v_exp_f32 v89, v89
    v_mfma_f32_32x32x16_bf16 v[128:143], a[64:67], v[160:163], 0
    ds_write_b128 v8, v[144:147] offset:0
    ds_write_b128 v8, v[148:151] offset:1024
    ds_write_b32 v9, v152 offset:2048
    v_exp_f32 v90, v90
    v_exp_f32 v91, v91
    v_exp_f32 v92, v92
    v_mfma_f32_32x32x16_bf16 v[128:143], a[68:71], v[164:167], v[128:143]
    v_exp_f32 v93, v93
    v_exp_f32 v94, v94
    v_exp_f32 v95, v95
    v_exp_f32 v96, v96
    v_cvt_pk_bf16_f32 v160, v80, v81
    v_exp_f32 v97, v97
    v_cvt_pk_bf16_f32 v161, v82, v83
    v_exp_f32 v98, v98
    v_cvt_pk_bf16_f32 v162, v84, v85
    v_exp_f32 v99, v99
    v_cvt_pk_bf16_f32 v163, v86, v87
    v_exp_f32 v100, v100
    v_mfma_f32_32x32x16_bf16 v[112:127], a[12:15], v[168:171], 0
    v_exp_f32 v101, v101
    v_cvt_pk_bf16_f32 v164, v88, v89
    v_exp_f32 v102, v102
    v_cvt_pk_bf16_f32 v165, v90, v91
    v_exp_f32 v103, v103
    v_cvt_pk_bf16_f32 v166, v92, v93
    v_exp_f32 v104, v104
    v_cvt_pk_bf16_f32 v167, v94, v95
    v_exp_f32 v105, v105
    v_mfma_f32_32x32x16_bf16 v[128:143], a[72:75], v[160:163], v[128:143]
    v_exp_f32 v106, v106
    v_exp_f32 v107, v107
    v_exp_f32 v108, v108
    v_mfma_f32_32x32x16_bf16 v[128:143], a[76:79], v[164:167], v[128:143]
    v_exp_f32 v109, v109
    v_exp_f32 v110, v110
    v_exp_f32 v111, v111
    v_exp_f32 v112, v112
    v_cvt_pk_bf16_f32 v160, v96, v97
    v_exp_f32 v113, v113
    v_cvt_pk_bf16_f32 v161, v98, v99
    v_exp_f32 v114, v114
    v_cvt_pk_bf16_f32 v162, v100, v101
    v_exp_f32 v115, v115
    v_cvt_pk_bf16_f32 v163, v102, v103
    v_exp_f32 v116, v116
    v_mfma_f32_32x32x16_bf16 v[64:79], a[16:19], v[168:171], 0
    v_exp_f32 v117, v117
    v_cvt_pk_bf16_f32 v164, v104, v105
    v_exp_f32 v118, v118
    v_cvt_pk_bf16_f32 v165, v106, v107
    v_exp_f32 v119, v119
    v_cvt_pk_bf16_f32 v166, v108, v109
    v_exp_f32 v120, v120
    v_cvt_pk_bf16_f32 v167, v110, v111
    v_exp_f32 v121, v121
    v_mfma_f32_32x32x16_bf16 v[128:143], a[80:83], v[160:163], v[128:143]
    v_exp_f32 v122, v122
    v_exp_f32 v123, v123
    v_exp_f32 v124, v124
    v_mfma_f32_32x32x16_bf16 v[128:143], a[84:87], v[164:167], v[128:143]
    v_exp_f32 v125, v125
    v_exp_f32 v126, v126
    v_exp_f32 v127, v127
    v_exp_f32 v64, v64
    v_cvt_pk_bf16_f32 v160, v112, v113
    v_exp_f32 v65, v65
    v_cvt_pk_bf16_f32 v161, v114, v115
    v_exp_f32 v66, v66
    v_cvt_pk_bf16_f32 v162, v116, v117
    v_exp_f32 v67, v67
    v_cvt_pk_bf16_f32 v163, v118, v119
    v_exp_f32 v68, v68
    v_mfma_f32_32x32x16_bf16 v[80:95], a[20:23], v[168:171], 0
    v_exp_f32 v69, v69
    v_cvt_pk_bf16_f32 v164, v120, v121
    v_exp_f32 v70, v70
    v_cvt_pk_bf16_f32 v165, v122, v123
    v_exp_f32 v71, v71
    v_cvt_pk_bf16_f32 v166, v124, v125
    v_exp_f32 v72, v72
    v_cvt_pk_bf16_f32 v167, v126, v127
    v_exp_f32 v73, v73
    v_mfma_f32_32x32x16_bf16 v[128:143], a[88:91], v[160:163], v[128:143]
    v_exp_f32 v74, v74
    v_exp_f32 v75, v75
    v_exp_f32 v76, v76
    v_mfma_f32_32x32x16_bf16 v[128:143], a[92:95], v[164:167], v[128:143]
    v_exp_f32 v77, v77
    v_exp_f32 v78, v78
    v_exp_f32 v79, v79
    v_exp_f32 v80, v80
    v_cvt_pk_bf16_f32 v160, v64, v65
    v_exp_f32 v81, v81
    v_cvt_pk_bf16_f32 v161, v66, v67
    v_exp_f32 v82, v82
    v_cvt_pk_bf16_f32 v162, v68, v69
    v_exp_f32 v83, v83
    v_cvt_pk_bf16_f32 v163, v70, v71
    v_exp_f32 v84, v84
    v_mfma_f32_32x32x16_bf16 v[96:111], a[24:27], v[168:171], 0
    v_exp_f32 v85, v85
    v_cvt_pk_bf16_f32 v164, v72, v73
    v_exp_f32 v86, v86
    v_cvt_pk_bf16_f32 v165, v74, v75
    v_exp_f32 v87, v87
    v_cvt_pk_bf16_f32 v166, v76, v77
    v_exp_f32 v88, v88
    v_cvt_pk_bf16_f32 v167, v78, v79
    v_exp_f32 v89, v89
    v_mfma_f32_32x32x16_bf16 v[128:143], a[96:99], v[160:163], v[128:143]
    v_exp_f32 v90, v90
    v_exp_f32 v91, v91
    v_exp_f32 v92, v92
    v_mfma_f32_32x32x16_bf16 v[128:143], a[100:103], v[164:167], v[128:143]
    v_exp_f32 v93, v93
    v_exp_f32 v94, v94
    v_exp_f32 v95, v95
    v_exp_f32 v96, v96
    v_cvt_pk_bf16_f32 v160, v80, v81
    v_exp_f32 v97, v97
    v_cvt_pk_bf16_f32 v161, v82, v83
    v_exp_f32 v98, v98
    v_cvt_pk_bf16_f32 v162, v84, v85
    v_exp_f32 v99, v99
    v_cvt_pk_bf16_f32 v163, v86, v87
    v_exp_f32 v100, v100
    v_mfma_f32_32x32x16_bf16 v[112:127], a[28:31], v[168:171], 0
    v_exp_f32 v101, v101
    v_cvt_pk_bf16_f32 v164, v88, v89
    v_exp_f32 v102, v102
    v_cvt_pk_bf16_f32 v165, v90, v91
    v_exp_f32 v103, v103
    v_cvt_pk_bf16_f32 v166, v92, v93
    v_exp_f32 v104, v104
    v_cvt_pk_bf16_f32 v167, v94, v95
    v_exp_f32 v105, v105
    v_mfma_f32_32x32x16_bf16 v[128:143], a[104:107], v[160:163], v[128:143]
    v_exp_f32 v106, v106
    v_exp_f32 v107, v107
    v_exp_f32 v108, v108
    v_mfma_f32_32x32x16_bf16 v[128:143], a[108:111], v[164:167], v[128:143]
    v_exp_f32 v109, v109
    v_exp_f32 v110, v110
    v_exp_f32 v111, v111
    v_exp_f32 v112, v112
    v_cvt_pk_bf16_f32 v160, v96, v97
    v_exp_f32 v113, v113
    v_cvt_pk_bf16_f32 v161, v98, v99
    v_exp_f32 v114, v114
    v_cvt_pk_bf16_f32 v162, v100, v101
    v_exp_f32 v115, v115
    v_cvt_pk_bf16_f32 v163, v102, v103
    v_exp_f32 v116, v116
    v_mfma_f32_32x32x16_bf16 v[64:79], a[32:35], v[168:171], 0
    v_exp_f32 v117, v117
    v_cvt_pk_bf16_f32 v164, v104, v105
    v_exp_f32 v118, v118
    v_cvt_pk_bf16_f32 v165, v106, v107
    v_exp_f32 v119, v119
    v_cvt_pk_bf16_f32 v166, v108, v109
    v_exp_f32 v120, v120
    v_cvt_pk_bf16_f32 v167, v110, v111
    v_exp_f32 v121, v121
    v_mfma_f32_32x32x16_bf16 v[128:143], a[112:115], v[160:163], v[128:143]
    v_exp_f32 v122, v122
    v_exp_f32 v123, v123
    v_exp_f32 v124, v124
    v_mfma_f32_32x32x16_bf16 v[128:143], a[116:119], v[164:167], v[128:143]
    v_exp_f32 v125, v125
    v_exp_f32 v126, v126
    v_exp_f32 v127, v127
    v_exp_f32 v64, v64
    v_cvt_pk_bf16_f32 v160, v112, v113
    v_exp_f32 v65, v65
    v_cvt_pk_bf16_f32 v161, v114, v115
    v_exp_f32 v66, v66
    v_cvt_pk_bf16_f32 v162, v116, v117
    v_exp_f32 v67, v67
    v_cvt_pk_bf16_f32 v163, v118, v119
    v_exp_f32 v68, v68
    v_mfma_f32_32x32x16_bf16 v[80:95], a[36:39], v[168:171], 0
    v_exp_f32 v69, v69
    v_cvt_pk_bf16_f32 v164, v120, v121
    v_exp_f32 v70, v70
    v_cvt_pk_bf16_f32 v165, v122, v123
    v_exp_f32 v71, v71
    v_cvt_pk_bf16_f32 v166, v124, v125
    v_exp_f32 v72, v72
    v_cvt_pk_bf16_f32 v167, v126, v127
    v_exp_f32 v73, v73
    v_mfma_f32_32x32x16_bf16 v[128:143], a[120:123], v[160:163], v[128:143]
    v_exp_f32 v74, v74
    v_exp_f32 v75, v75
    v_exp_f32 v76, v76
    v_mfma_f32_32x32x16_bf16 v[128:143], a[124:127], v[164:167], v[128:143]
    v_exp_f32 v77, v77
    v_exp_f32 v78, v78
    v_exp_f32 v79, v79
    v_exp_f32 v80, v80
    v_cvt_pk_bf16_f32 v160, v64, v65
    v_exp_f32 v81, v81
    v_cvt_pk_bf16_f32 v161, v66, v67
    v_exp_f32 v82, v82
    v_cvt_pk_bf16_f32 v162, v68, v69
    v_exp_f32 v83, v83
    v_cvt_pk_bf16_f32 v163, v70, v71
    v_exp_f32 v84, v84
    v_mfma_f32_32x32x16_bf16 v[96:111], a[40:43], v[168:171], 0
    v_exp_f32 v85, v85
    v_cvt_pk_bf16_f32 v164, v72, v73
    v_exp_f32 v86, v86
    v_cvt_pk_bf16_f32 v165, v74, v75
    v_exp_f32 v87, v87
    v_cvt_pk_bf16_f32 v166, v76, v77
    v_exp_f32 v88, v88
    v_cvt_pk_bf16_f32 v167, v78, v79
    v_exp_f32 v89, v89
    v_mfma_f32_32x32x16_bf16 v[128:143], a[128:131], v[160:163], v[128:143]
    v_exp_f32 v90, v90
    v_exp_f32 v91, v91
    v_exp_f32 v92, v92
    v_mfma_f32_32x32x16_bf16 v[128:143], a[132:135], v[164:167], v[128:143]
    v_exp_f32 v93, v93
    v_exp_f32 v94, v94
    v_exp_f32 v95, v95
    v_exp_f32 v96, v96
    v_cvt_pk_bf16_f32 v160, v80, v81
    v_exp_f32 v97, v97
    v_cvt_pk_bf16_f32 v161, v82, v83
    v_exp_f32 v98, v98
    v_cvt_pk_bf16_f32 v162, v84, v85
    v_exp_f32 v99, v99
    v_cvt_pk_bf16_f32 v163, v86, v87
    v_exp_f32 v100, v100
    v_mfma_f32_32x32x16_bf16 v[112:127], a[44:47], v[168:171], 0
    v_exp_f32 v101, v101
    v_cvt_pk_bf16_f32 v164, v88, v89
    v_exp_f32 v102, v102
    v_cvt_pk_bf16_f32 v165, v90, v91
    v_exp_f32 v103, v103
    v_cvt_pk_bf16_f32 v166, v92, v93
    v_exp_f32 v104, v104
    v_cvt_pk_bf16_f32 v167, v94, v95
    v_exp_f32 v105, v105
    v_mfma_f32_32x32x16_bf16 v[128:143], a[136:139], v[160:163], v[128:143]
    v_exp_f32 v106, v106
    v_exp_f32 v107, v107
    v_exp_f32 v108, v108
    v_mfma_f32_32x32x16_bf16 v[128:143], a[140:143], v[164:167], v[128:143]
    v_exp_f32 v109, v109
    v_exp_f32 v110, v110
    v_exp_f32 v111, v111
    v_exp_f32 v112, v112
    v_cvt_pk_bf16_f32 v160, v96, v97
    v_exp_f32 v113, v113
    v_cvt_pk_bf16_f32 v161, v98, v99
    v_exp_f32 v114, v114
    v_cvt_pk_bf16_f32 v162, v100, v101
    v_exp_f32 v115, v115
    v_cvt_pk_bf16_f32 v163, v102, v103
    v_exp_f32 v116, v116
    v_mfma_f32_32x32x16_bf16 v[64:79], a[48:51], v[168:171], 0
    v_exp_f32 v117, v117
    v_cvt_pk_bf16_f32 v164, v104, v105
    v_exp_f32 v118, v118
    v_cvt_pk_bf16_f32 v165, v106, v107
    v_exp_f32 v119, v119
    v_cvt_pk_bf16_f32 v166, v108, v109
    v_exp_f32 v120, v120
    v_cvt_pk_bf16_f32 v167, v110, v111
    v_exp_f32 v121, v121
    v_mfma_f32_32x32x16_bf16 v[128:143], a[144:147], v[160:163], v[128:143]
    v_exp_f32 v122, v122
    v_exp_f32 v123, v123
    v_exp_f32 v124, v124
    v_mfma_f32_32x32x16_bf16 v[128:143], a[148:151], v[164:167], v[128:143]
    v_exp_f32 v125, v125
    v_exp_f32 v126, v126
    v_exp_f32 v127, v127
    v_exp_f32 v64, v64
    v_cvt_pk_bf16_f32 v160, v112, v113
    v_exp_f32 v65, v65
    v_cvt_pk_bf16_f32 v161, v114, v115
    v_exp_f32 v66, v66
    v_cvt_pk_bf16_f32 v162, v116, v117
    v_exp_f32 v67, v67
    v_cvt_pk_bf16_f32 v163, v118, v119
    v_exp_f32 v68, v68
    v_mfma_f32_32x32x16_bf16 v[80:95], a[52:55], v[168:171], 0
    v_exp_f32 v69, v69
    v_cvt_pk_bf16_f32 v164, v120, v121
    v_exp_f32 v70, v70
    v_cvt_pk_bf16_f32 v165, v122, v123
    v_exp_f32 v71, v71
    v_cvt_pk_bf16_f32 v166, v124, v125
    v_exp_f32 v72, v72
    v_cvt_pk_bf16_f32 v167, v126, v127
    v_exp_f32 v73, v73
    v_mfma_f32_32x32x16_bf16 v[128:143], a[152:155], v[160:163], v[128:143]
    v_exp_f32 v74, v74
    v_exp_f32 v75, v75
    v_exp_f32 v76, v76
    v_mfma_f32_32x32x16_bf16 v[128:143], a[156:159], v[164:167], v[128:143]
    v_exp_f32 v77, v77
    v_exp_f32 v78, v78
    v_exp_f32 v79, v79
    v_exp_f32 v80, v80
    v_cvt_pk_bf16_f32 v160, v64, v65
    v_exp_f32 v81, v81
    v_cvt_pk_bf16_f32 v161, v66, v67
    v_exp_f32 v82, v82
    v_cvt_pk_bf16_f32 v162, v68, v69
    v_exp_f32 v83, v83
    v_cvt_pk_bf16_f32 v163, v70, v71
    v_exp_f32 v84, v84
    v_mfma_f32_32x32x16_bf16 v[96:111], a[56:59], v[168:171], 0
    v_exp_f32 v85, v85
    v_cvt_pk_bf16_f32 v164, v72, v73
    v_exp_f32 v86, v86
    v_cvt_pk_bf16_f32 v165, v74, v75
    v_exp_f32 v87, v87
    v_cvt_pk_bf16_f32 v166, v76, v77
    v_exp_f32 v88, v88
    v_cvt_pk_bf16_f32 v167, v78, v79
    v_exp_f32 v89, v89
    v_mfma_f32_32x32x16_bf16 v[128:143], a[160:163], v[160:163], v[128:143]
    v_exp_f32 v90, v90
    v_exp_f32 v91, v91
    v_exp_f32 v92, v92
    v_mfma_f32_32x32x16_bf16 v[128:143], a[164:167], v[164:167], v[128:143]
    v_exp_f32 v93, v93
    v_exp_f32 v94, v94
    v_exp_f32 v95, v95
    v_exp_f32 v96, v96
    v_cvt_pk_bf16_f32 v160, v80, v81
    v_exp_f32 v97, v97
    v_cvt_pk_bf16_f32 v161, v82, v83
    v_exp_f32 v98, v98
    v_cvt_pk_bf16_f32 v162, v84, v85
    v_exp_f32 v99, v99
    v_cvt_pk_bf16_f32 v163, v86, v87
    v_exp_f32 v100, v100
    v_mfma_f32_32x32x16_bf16 v[112:127], a[60:63], v[168:171], 0
    v_exp_f32 v101, v101
    v_cvt_pk_bf16_f32 v164, v88, v89
    v_exp_f32 v102, v102
    v_cvt_pk_bf16_f32 v165, v90, v91
    v_exp_f32 v103, v103
    v_cvt_pk_bf16_f32 v166, v92, v93
    v_exp_f32 v104, v104
    v_cvt_pk_bf16_f32 v167, v94, v95
    v_exp_f32 v105, v105
    v_mfma_f32_32x32x16_bf16 v[128:143], a[168:171], v[160:163], v[128:143]
    v_exp_f32 v106, v106
    v_exp_f32 v107, v107
    v_exp_f32 v108, v108
    v_mfma_f32_32x32x16_bf16 v[128:143], a[172:175], v[164:167], v[128:143]
    v_exp_f32 v109, v109
    v_exp_f32 v110, v110
    v_exp_f32 v111, v111
    v_exp_f32 v112, v112
    v_cvt_pk_bf16_f32 v160, v96, v97
    v_exp_f32 v113, v113
    v_cvt_pk_bf16_f32 v161, v98, v99
    v_exp_f32 v114, v114
    v_cvt_pk_bf16_f32 v162, v100, v101
    v_exp_f32 v115, v115
    v_cvt_pk_bf16_f32 v163, v102, v103
    v_exp_f32 v116, v116
    s_waitcnt vmcnt(0)
    v_mfma_f32_32x32x16_bf16 v[64:79], a[0:3], v[172:175], 0
    v_exp_f32 v117, v117
    v_cvt_pk_bf16_f32 v164, v104, v105
    v_exp_f32 v118, v118
    v_cvt_pk_bf16_f32 v165, v106, v107
    v_exp_f32 v119, v119
    v_cvt_pk_bf16_f32 v166, v108, v109
    v_exp_f32 v120, v120
    v_cvt_pk_bf16_f32 v167, v110, v111
    v_exp_f32 v121, v121
    v_mfma_f32_32x32x16_bf16 v[128:143], a[176:179], v[160:163], v[128:143]
    v_exp_f32 v122, v122
    v_exp_f32 v123, v123
    v_exp_f32 v124, v124
    v_mfma_f32_32x32x16_bf16 v[128:143], a[180:183], v[164:167], v[128:143]
    v_exp_f32 v125, v125
    v_exp_f32 v126, v126
    v_exp_f32 v127, v127
    v_exp_f32 v64, v64
    v_cvt_pk_bf16_f32 v160, v112, v113
    v_exp_f32 v65, v65
    v_cvt_pk_bf16_f32 v161, v114, v115
    v_exp_f32 v66, v66
    v_cvt_pk_bf16_f32 v162, v116, v117
    v_exp_f32 v67, v67
    v_cvt_pk_bf16_f32 v163, v118, v119
    v_exp_f32 v68, v68
    v_mfma_f32_32x32x16_bf16 v[80:95], a[4:7], v[172:175], 0
    buffer_load_dwordx4 v[168:171], v3, s[8:11], s28 offen sc1
    s_add_u32 s28, s28, 1024
    v_exp_f32 v69, v69
    v_cvt_pk_bf16_f32 v164, v120, v121
    v_exp_f32 v70, v70
    v_cvt_pk_bf16_f32 v165, v122, v123
    v_exp_f32 v71, v71
    v_cvt_pk_bf16_f32 v166, v124, v125
    v_exp_f32 v72, v72
    v_cvt_pk_bf16_f32 v167, v126, v127
    v_exp_f32 v73, v73
    v_mfma_f32_32x32x16_bf16 v[128:143], a[184:187], v[160:163], v[128:143]
    v_exp_f32 v74, v74
    v_exp_f32 v75, v75
    v_exp_f32 v76, v76
    v_mfma_f32_32x32x16_bf16 v[128:143], a[188:191], v[164:167], v[128:143]
    v_exp_f32 v77, v77
    v_exp_f32 v78, v78
    v_exp_f32 v79, v79
    v_exp_f32 v80, v80
    v_cvt_pk_bf16_f32 v160, v64, v65
    v_exp_f32 v81, v81
    v_cvt_pk_bf16_f32 v161, v66, v67
    v_exp_f32 v82, v82
    v_cvt_pk_bf16_f32 v162, v68, v69
    v_exp_f32 v83, v83
    v_cvt_pk_bf16_f32 v163, v70, v71
    v_exp_f32 v84, v84
    v_mfma_f32_32x32x16_bf16 v[96:111], a[8:11], v[172:175], 0
    v_exp_f32 v85, v85
    v_cvt_pk_bf16_f32 v164, v72, v73
    v_exp_f32 v86, v86
    v_cvt_pk_bf16_f32 v165, v74, v75
    v_exp_f32 v87, v87
    v_cvt_pk_bf16_f32 v166, v76, v77
    v_exp_f32 v88, v88
    v_cvt_pk_bf16_f32 v167, v78, v79
    v_exp_f32 v89, v89
    v_mfma_f32_32x32x16_bf16 v[144:159], a[64:67], v[160:163], 0
    ds_write_b128 v8, v[128:131] offset:9216
    ds_write_b128 v8, v[132:135] offset:10240
    ds_write_b32 v9, v136 offset:11264
    v_exp_f32 v90, v90
    v_exp_f32 v91, v91
    v_exp_f32 v92, v92
    v_mfma_f32_32x32x16_bf16 v[144:159], a[68:71], v[164:167], v[144:159]
    v_exp_f32 v93, v93
    v_exp_f32 v94, v94
    v_exp_f32 v95, v95
    v_exp_f32 v96, v96
    v_cvt_pk_bf16_f32 v160, v80, v81
    v_exp_f32 v97, v97
    v_cvt_pk_bf16_f32 v161, v82, v83
    v_exp_f32 v98, v98
    v_cvt_pk_bf16_f32 v162, v84, v85
    v_exp_f32 v99, v99
    v_cvt_pk_bf16_f32 v163, v86, v87
    v_exp_f32 v100, v100
    v_mfma_f32_32x32x16_bf16 v[112:127], a[12:15], v[172:175], 0
    v_exp_f32 v101, v101
    v_cvt_pk_bf16_f32 v164, v88, v89
    v_exp_f32 v102, v102
    v_cvt_pk_bf16_f32 v165, v90, v91
    v_exp_f32 v103, v103
    v_cvt_pk_bf16_f32 v166, v92, v93
    v_exp_f32 v104, v104
    v_cvt_pk_bf16_f32 v167, v94, v95
    v_exp_f32 v105, v105
    v_mfma_f32_32x32x16_bf16 v[144:159], a[72:75], v[160:163], v[144:159]
    v_exp_f32 v106, v106
    v_exp_f32 v107, v107
    v_exp_f32 v108, v108
    v_mfma_f32_32x32x16_bf16 v[144:159], a[76:79], v[164:167], v[144:159]
    v_exp_f32 v109, v109
    v_exp_f32 v110, v110
    v_exp_f32 v111, v111
    v_exp_f32 v112, v112
    v_cvt_pk_bf16_f32 v160, v96, v97
    v_exp_f32 v113, v113
    v_cvt_pk_bf16_f32 v161, v98, v99
    v_exp_f32 v114, v114
    v_cvt_pk_bf16_f32 v162, v100, v101
    v_exp_f32 v115, v115
    v_cvt_pk_bf16_f32 v163, v102, v103
    v_exp_f32 v116, v116
    v_mfma_f32_32x32x16_bf16 v[64:79], a[16:19], v[172:175], 0
    v_exp_f32 v117, v117
    v_cvt_pk_bf16_f32 v164, v104, v105
    v_exp_f32 v118, v118
    v_cvt_pk_bf16_f32 v165, v106, v107
    v_exp_f32 v119, v119
    v_cvt_pk_bf16_f32 v166, v108, v109
    v_exp_f32 v120, v120
    v_cvt_pk_bf16_f32 v167, v110, v111
    v_exp_f32 v121, v121
    v_mfma_f32_32x32x16_bf16 v[144:159], a[80:83], v[160:163], v[144:159]
    v_exp_f32 v122, v122
    v_exp_f32 v123, v123
    v_exp_f32 v124, v124
    v_mfma_f32_32x32x16_bf16 v[144:159], a[84:87], v[164:167], v[144:159]
    v_exp_f32 v125, v125
    v_exp_f32 v126, v126
    v_exp_f32 v127, v127
    v_exp_f32 v64, v64
    v_cvt_pk_bf16_f32 v160, v112, v113
    v_exp_f32 v65, v65
    v_cvt_pk_bf16_f32 v161, v114, v115
    v_exp_f32 v66, v66
    v_cvt_pk_bf16_f32 v162, v116, v117
    v_exp_f32 v67, v67
    v_cvt_pk_bf16_f32 v163, v118, v119
    v_exp_f32 v68, v68
    v_mfma_f32_32x32x16_bf16 v[80:95], a[20:23], v[172:175], 0
    v_exp_f32 v69, v69
    v_cvt_pk_bf16_f32 v164, v120, v121
    v_exp_f32 v70, v70
    v_cvt_pk_bf16_f32 v165, v122, v123
    v_exp_f32 v71, v71
    v_cvt_pk_bf16_f32 v166, v124, v125
    v_exp_f32 v72, v72
    v_cvt_pk_bf16_f32 v167, v126, v127
    v_exp_f32 v73, v73
    v_mfma_f32_32x32x16_bf16 v[144:159], a[88:91], v[160:163], v[144:159]
    v_exp_f32 v74, v74
    v_exp_f32 v75, v75
    v_exp_f32 v76, v76
    v_mfma_f32_32x32x16_bf16 v[144:159], a[92:95], v[164:167], v[144:159]
    v_exp_f32 v77, v77
    v_exp_f32 v78, v78
    v_exp_f32 v79, v79
    v_exp_f32 v80, v80
    v_cvt_pk_bf16_f32 v160, v64, v65
    v_exp_f32 v81, v81
    v_cvt_pk_bf16_f32 v161, v66, v67
    v_exp_f32 v82, v82
    v_cvt_pk_bf16_f32 v162, v68, v69
    v_exp_f32 v83, v83
    v_cvt_pk_bf16_f32 v163, v70, v71
    v_exp_f32 v84, v84
    v_mfma_f32_32x32x16_bf16 v[96:111], a[24:27], v[172:175], 0
    v_exp_f32 v85, v85
    v_cvt_pk_bf16_f32 v164, v72, v73
    v_exp_f32 v86, v86
    v_cvt_pk_bf16_f32 v165, v74, v75
    v_exp_f32 v87, v87
    v_cvt_pk_bf16_f32 v166, v76, v77
    v_exp_f32 v88, v88
    v_cvt_pk_bf16_f32 v167, v78, v79
    v_exp_f32 v89, v89
    v_mfma_f32_32x32x16_bf16 v[144:159], a[96:99], v[160:163], v[144:159]
    v_exp_f32 v90, v90
    v_exp_f32 v91, v91
    v_exp_f32 v92, v92
    v_mfma_f32_32x32x16_bf16 v[144:159], a[100:103], v[164:167], v[144:159]
    v_exp_f32 v93, v93
    v_exp_f32 v94, v94
    v_exp_f32 v95, v95
    v_exp_f32 v96, v96
    v_cvt_pk_bf16_f32 v160, v80, v81
    v_exp_f32 v97, v97
    v_cvt_pk_bf16_f32 v161, v82, v83
    v_exp_f32 v98, v98
    v_cvt_pk_bf16_f32 v162, v84, v85
    v_exp_f32 v99, v99
    v_cvt_pk_bf16_f32 v163, v86, v87
    v_exp_f32 v100, v100
    v_mfma_f32_32x32x16_bf16 v[112:127], a[28:31], v[172:175], 0
    v_exp_f32 v101, v101
    v_cvt_pk_bf16_f32 v164, v88, v89
    v_exp_f32 v102, v102
    v_cvt_pk_bf16_f32 v165, v90, v91
    v_exp_f32 v103, v103
    v_cvt_pk_bf16_f32 v166, v92, v93
    v_exp_f32 v104, v104
    v_cvt_pk_bf16_f32 v167, v94, v95
    v_exp_f32 v105, v105
    v_mfma_f32_32x32x16_bf16 v[144:159], a[104:107], v[160:163], v[144:159]
    v_exp_f32 v106, v106
    v_exp_f32 v107, v107
    v_exp_f32 v108, v108
    v_mfma_f32_32x32x16_bf16 v[144:159], a[108:111], v[164:167], v[144:159]
    v_exp_f32 v109, v109
    v_exp_f32 v110, v110
    v_exp_f32 v111, v111
    v_exp_f32 v112, v112
    v_cvt_pk_bf16_f32 v160, v96, v97
    v_exp_f32 v113, v113
    v_cvt_pk_bf16_f32 v161, v98, v99
    v_exp_f32 v114, v114
    v_cvt_pk_bf16_f32 v162, v100, v101
    v_exp_f32 v115, v115
    v_cvt_pk_bf16_f32 v163, v102, v103
    v_exp_f32 v116, v116
    v_mfma_f32_32x32x16_bf16 v[64:79], a[32:35], v[172:175], 0
    v_exp_f32 v117, v117
    v_cvt_pk_bf16_f32 v164, v104, v105
    v_exp_f32 v118, v118
    v_cvt_pk_bf16_f32 v165, v106, v107
    v_exp_f32 v119, v119
    v_cvt_pk_bf16_f32 v166, v108, v109
    v_exp_f32 v120, v120
    v_cvt_pk_bf16_f32 v167, v110, v111
    v_exp_f32 v121, v121
    v_mfma_f32_32x32x16_bf16 v[144:159], a[112:115], v[160:163], v[144:159]
    v_exp_f32 v122, v122
    v_exp_f32 v123, v123
    v_exp_f32 v124, v124
    v_mfma_f32_32x32x16_bf16 v[144:159], a[116:119], v[164:167], v[144:159]
    v_exp_f32 v125, v125
    v_exp_f32 v126, v126
    v_exp_f32 v127, v127
    v_exp_f32 v64, v64
    v_cvt_pk_bf16_f32 v160, v112, v113
    v_exp_f32 v65, v65
    v_cvt_pk_bf16_f32 v161, v114, v115
    v_exp_f32 v66, v66
    v_cvt_pk_bf16_f32 v162, v116, v117
    v_exp_f32 v67, v67
    v_cvt_pk_bf16_f32 v163, v118, v119
    v_exp_f32 v68, v68
    v_mfma_f32_32x32x16_bf16 v[80:95], a[36:39], v[172:175], 0
    v_exp_f32 v69, v69
    v_cvt_pk_bf16_f32 v164, v120, v121
    v_exp_f32 v70, v70
    v_cvt_pk_bf16_f32 v165, v122, v123
    v_exp_f32 v71, v71
    v_cvt_pk_bf16_f32 v166, v124, v125
    v_exp_f32 v72, v72
    v_cvt_pk_bf16_f32 v167, v126, v127
    v_exp_f32 v73, v73
    v_mfma_f32_32x32x16_bf16 v[144:159], a[120:123], v[160:163], v[144:159]
    v_exp_f32 v74, v74
    v_exp_f32 v75, v75
    v_exp_f32 v76, v76
    v_mfma_f32_32x32x16_bf16 v[144:159], a[124:127], v[164:167], v[144:159]
    v_exp_f32 v77, v77
    v_exp_f32 v78, v78
    v_exp_f32 v79, v79
    v_exp_f32 v80, v80
    v_cvt_pk_bf16_f32 v160, v64, v65
    v_exp_f32 v81, v81
    v_cvt_pk_bf16_f32 v161, v66, v67
    v_exp_f32 v82, v82
    v_cvt_pk_bf16_f32 v162, v68, v69
    v_exp_f32 v83, v83
    v_cvt_pk_bf16_f32 v163, v70, v71
    v_exp_f32 v84, v84
    v_mfma_f32_32x32x16_bf16 v[96:111], a[40:43], v[172:175], 0
    v_exp_f32 v85, v85
    v_cvt_pk_bf16_f32 v164, v72, v73
    v_exp_f32 v86, v86
    v_cvt_pk_bf16_f32 v165, v74, v75
    v_exp_f32 v87, v87
    v_cvt_pk_bf16_f32 v166, v76, v77
    v_exp_f32 v88, v88
    v_cvt_pk_bf16_f32 v167, v78, v79
    v_exp_f32 v89, v89
    v_mfma_f32_32x32x16_bf16 v[144:159], a[128:131], v[160:163], v[144:159]
    v_exp_f32 v90, v90
    v_exp_f32 v91, v91
    v_exp_f32 v92, v92
    v_mfma_f32_32x32x16_bf16 v[144:159], a[132:135], v[164:167], v[144:159]
    v_exp_f32 v93, v93
    v_exp_f32 v94, v94
    v_exp_f32 v95, v95
    v_exp_f32 v96, v96
    v_cvt_pk_bf16_f32 v160, v80, v81
    v_exp_f32 v97, v97
    v_cvt_pk_bf16_f32 v161, v82, v83
    v_exp_f32 v98, v98
    v_cvt_pk_bf16_f32 v162, v84, v85
    v_exp_f32 v99, v99
    v_cvt_pk_bf16_f32 v163, v86, v87
    v_exp_f32 v100, v100
    v_mfma_f32_32x32x16_bf16 v[112:127], a[44:47], v[172:175], 0
    v_exp_f32 v101, v101
    v_cvt_pk_bf16_f32 v164, v88, v89
    v_exp_f32 v102, v102
    v_cvt_pk_bf16_f32 v165, v90, v91
    v_exp_f32 v103, v103
    v_cvt_pk_bf16_f32 v166, v92, v93
    v_exp_f32 v104, v104
    v_cvt_pk_bf16_f32 v167, v94, v95
    v_exp_f32 v105, v105
    v_mfma_f32_32x32x16_bf16 v[144:159], a[136:139], v[160:163], v[144:159]
    v_exp_f32 v106, v106
    v_exp_f32 v107, v107
    v_exp_f32 v108, v108
    v_mfma_f32_32x32x16_bf16 v[144:159], a[140:143], v[164:167], v[144:159]
    v_exp_f32 v109, v109
    v_exp_f32 v110, v110
    v_exp_f32 v111, v111
    v_exp_f32 v112, v112
    v_cvt_pk_bf16_f32 v160, v96, v97
    v_exp_f32 v113, v113
    v_cvt_pk_bf16_f32 v161, v98, v99
    v_exp_f32 v114, v114
    v_cvt_pk_bf16_f32 v162, v100, v101
    v_exp_f32 v115, v115
    v_cvt_pk_bf16_f32 v163, v102, v103
    v_exp_f32 v116, v116
    v_mfma_f32_32x32x16_bf16 v[64:79], a[48:51], v[172:175], 0
    v_exp_f32 v117, v117
    v_cvt_pk_bf16_f32 v164, v104, v105
    v_exp_f32 v118, v118
    v_cvt_pk_bf16_f32 v165, v106, v107
    v_exp_f32 v119, v119
    v_cvt_pk_bf16_f32 v166, v108, v109
    v_exp_f32 v120, v120
    v_cvt_pk_bf16_f32 v167, v110, v111
    v_exp_f32 v121, v121
    v_mfma_f32_32x32x16_bf16 v[144:159], a[144:147], v[160:163], v[144:159]
    v_exp_f32 v122, v122
    v_exp_f32 v123, v123
    v_exp_f32 v124, v124
    v_mfma_f32_32x32x16_bf16 v[144:159], a[148:151], v[164:167], v[144:159]
    v_exp_f32 v125, v125
    v_exp_f32 v126, v126
    v_exp_f32 v127, v127
    v_exp_f32 v64, v64
    v_cvt_pk_bf16_f32 v160, v112, v113
    v_exp_f32 v65, v65
    v_cvt_pk_bf16_f32 v161, v114, v115
    v_exp_f32 v66, v66
    v_cvt_pk_bf16_f32 v162, v116, v117
    v_exp_f32 v67, v67
    v_cvt_pk_bf16_f32 v163, v118, v119
    v_exp_f32 v68, v68
    v_mfma_f32_32x32x16_bf16 v[80:95], a[52:55], v[172:175], 0
    v_exp_f32 v69, v69
    v_cvt_pk_bf16_f32 v164, v120, v121
    v_exp_f32 v70, v70
    v_cvt_pk_bf16_f32 v165, v122, v123
    v_exp_f32 v71, v71
    v_cvt_pk_bf16_f32 v166, v124, v125
    v_exp_f32 v72, v72
    v_cvt_pk_bf16_f32 v167, v126, v127
    v_exp_f32 v73, v73
    v_mfma_f32_32x32x16_bf16 v[144:159], a[152:155], v[160:163], v[144:159]
    v_exp_f32 v74, v74
    v_exp_f32 v75, v75
    v_exp_f32 v76, v76
    v_mfma_f32_32x32x16_bf16 v[144:159], a[156:159], v[164:167], v[144:159]
    v_exp_f32 v77, v77
    v_exp_f32 v78, v78
    v_exp_f32 v79, v79
    v_exp_f32 v80, v80
    v_cvt_pk_bf16_f32 v160, v64, v65
    v_exp_f32 v81, v81
    v_cvt_pk_bf16_f32 v161, v66, v67
    v_exp_f32 v82, v82
    v_cvt_pk_bf16_f32 v162, v68, v69
    v_exp_f32 v83, v83
    v_cvt_pk_bf16_f32 v163, v70, v71
    v_exp_f32 v84, v84
    v_mfma_f32_32x32x16_bf16 v[96:111], a[56:59], v[172:175], 0
    v_exp_f32 v85, v85
    v_cvt_pk_bf16_f32 v164, v72, v73
    v_exp_f32 v86, v86
    v_cvt_pk_bf16_f32 v165, v74, v75
    v_exp_f32 v87, v87
    v_cvt_pk_bf16_f32 v166, v76, v77
    v_exp_f32 v88, v88
    v_cvt_pk_bf16_f32 v167, v78, v79
    v_exp_f32 v89, v89
    v_mfma_f32_32x32x16_bf16 v[144:159], a[160:163], v[160:163], v[144:159]
    v_exp_f32 v90, v90
    v_exp_f32 v91, v91
    v_exp_f32 v92, v92
    v_mfma_f32_32x32x16_bf16 v[144:159], a[164:167], v[164:167], v[144:159]
    v_exp_f32 v93, v93
    v_exp_f32 v94, v94
    v_exp_f32 v95, v95
    v_exp_f32 v96, v96
    v_cvt_pk_bf16_f32 v160, v80, v81
    v_exp_f32 v97, v97
    v_cvt_pk_bf16_f32 v161, v82, v83
    v_exp_f32 v98, v98
    v_cvt_pk_bf16_f32 v162, v84, v85
    v_exp_f32 v99, v99
    v_cvt_pk_bf16_f32 v163, v86, v87
    v_exp_f32 v100, v100
    v_mfma_f32_32x32x16_bf16 v[112:127], a[60:63], v[172:175], 0
    v_exp_f32 v101, v101
    v_cvt_pk_bf16_f32 v164, v88, v89
    v_exp_f32 v102, v102
    v_cvt_pk_bf16_f32 v165, v90, v91
    v_exp_f32 v103, v103
    v_cvt_pk_bf16_f32 v166, v92, v93
    v_exp_f32 v104, v104
    v_cvt_pk_bf16_f32 v167, v94, v95
    v_exp_f32 v105, v105
    v_mfma_f32_32x32x16_bf16 v[144:159], a[168:171], v[160:163], v[144:159]
    v_exp_f32 v106, v106
    v_exp_f32 v107, v107
    v_exp_f32 v108, v108
    v_mfma_f32_32x32x16_bf16 v[144:159], a[172:175], v[164:167], v[144:159]
    v_exp_f32 v109, v109
    v_exp_f32 v110, v110
    v_exp_f32 v111, v111
    v_exp_f32 v112, v112
    v_cvt_pk_bf16_f32 v160, v96, v97
    v_exp_f32 v113, v113
    v_cvt_pk_bf16_f32 v161, v98, v99
    v_exp_f32 v114, v114
    v_cvt_pk_bf16_f32 v162, v100, v101
    v_exp_f32 v115, v115
    v_cvt_pk_bf16_f32 v163, v102, v103
    v_exp_f32 v116, v116
    s_waitcnt vmcnt(0)
    v_mfma_f32_32x32x16_bf16 v[64:79], a[0:3], v[168:171], 0
    v_exp_f32 v117, v117
    v_cvt_pk_bf16_f32 v164, v104, v105
    v_exp_f32 v118, v118
    v_cvt_pk_bf16_f32 v165, v106, v107
    v_exp_f32 v119, v119
    v_cvt_pk_bf16_f32 v166, v108, v109
    v_exp_f32 v120, v120
    v_cvt_pk_bf16_f32 v167, v110, v111
    v_exp_f32 v121, v121
    v_mfma_f32_32x32x16_bf16 v[144:159], a[176:179], v[160:163], v[144:159]
    v_exp_f32 v122, v122
    v_exp_f32 v123, v123
    v_exp_f32 v124, v124
    v_mfma_f32_32x32x16_bf16 v[144:159], a[180:183], v[164:167], v[144:159]
    v_exp_f32 v125, v125
    v_exp_f32 v126, v126
    v_exp_f32 v127, v127
    v_add_u32 v8, 18432, v8
    v_add_u32 v9, 18432, v9
    s_sub_u32 s35, s35, 1
    s_cmp_lg_u32 s35, 0
    s_cbranch_scc1 mg_ATT
    v_cvt_pk_bf16_f32 v160, v112, v113
    v_cvt_pk_bf16_f32 v161, v114, v115
    v_cvt_pk_bf16_f32 v162, v116, v117
    v_cvt_pk_bf16_f32 v163, v118, v119
    v_cvt_pk_bf16_f32 v164, v120, v121
    v_cvt_pk_bf16_f32 v165, v122, v123
    v_cvt_pk_bf16_f32 v166, v124, v125
    v_cvt_pk_bf16_f32 v167, v126, v127
    v_mfma_f32_32x32x16_bf16 v[144:159], a[184:187], v[160:163], v[144:159]
    s_nop 0
    v_mfma_f32_32x32x16_bf16 v[144:159], a[188:191], v[164:167], v[144:159]
    s_nop 7
    s_nop 7
    ds_write_b128 v8, v[144:147] offset:0
    ds_write_b128 v8, v[148:151] offset:1024
    ds_write_b32 v9, v152 offset:2048
    s_mov_b32 s47, 0
mg_RED:
    v_lshlrev_b32 v7, 4, v4
    s_mul_i32 s28, s22, 3584
    s_add_u32 s28, s28, 49577984
    buffer_load_dwordx4 v[32:35], v7, s[8:11], s28 offen offset:0 sc1
    buffer_load_dwordx4 v[36:39], v7, s[8:11], s28 offen offset:512 sc1
    buffer_load_dwordx4 v[40:43], v7, s[8:11], s28 offen offset:1024 sc1
    buffer_load_dwordx4 v[44:47], v7, s[8:11], s28 offen offset:1536 sc1
    buffer_load_dwordx4 v[48:51], v7, s[8:11], s28 offen offset:2048 sc1
    buffer_load_dwordx4 v[52:55], v7, s[8:11], s28 offen offset:2560 sc1
    buffer_load_dwordx4 v[56:59], v7, s[8:11], s28 offen offset:3072 sc1
    s_waitcnt lgkmcnt(0)
    s_barrier
    s_mul_i32 s34, s20, 18432
    s_add_u32 s34, s34, 9216
    v_add_u32 v10, s34, v3
    v_lshl_add_u32 v11, v1, 2, s34
    ds_read_b128 v[64:67], v10 offset:0
    ds_read_b128 v[68:71], v10 offset:1024
    ds_read_b32 v72, v11 offset:2048
    ds_read_b128 v[76:79], v10 offset:2304
    ds_read_b128 v[80:83], v10 offset:3328
    ds_read_b32 v84, v11 offset:4352
    ds_read_b128 v[88:91], v10 offset:4608
    ds_read_b128 v[92:95], v10 offset:5632
    ds_read_b32 v96, v11 offset:6656
    ds_read_b128 v[100:103], v10 offset:6912
    ds_read_b128 v[104:107], v10 offset:7936
    ds_read_b32 v108, v11 offset:8960
    ds_read_b128 v[112:115], v10 offset:9216
    ds_read_b128 v[116:119], v10 offset:10240
    ds_read_b32 v120, v11 offset:11264
    ds_read_b128 v[124:127], v10 offset:11520
    ds_read_b128 v[128:131], v10 offset:12544
    ds_read_b32 v132, v11 offset:13568
    ds_read_b128 v[136:139], v10 offset:13824
    ds_read_b128 v[140:143], v10 offset:14848
    ds_read_b32 v144, v11 offset:15872
    ds_read_b128 v[148:151], v10 offset:16128
    ds_read_b128 v[152:155], v10 offset:17152
    ds_read_b32 v156, v11 offset:18176
    s_mov_b32 s36, 0x21800000
    s_mov_b32 s37, 0x5d800000
    s_lshl_b32 s38, s26, 3
    s_lshl_b32 s39, s20, 1
    s_add_u32 s38, s38, s39
    s_lshl_b32 s38, s38, 5
    s_add_u32 s38, s38, s25
    s_lshl_b32 s38, s38, 10
    s_add_u32 s38, s38, 10485760
    s_add_u32 s38, s38, s7
    s_add_u32 s39, s38, 32768
    s_mov_b64 s[48:49], -1
    s_waitcnt lgkmcnt(12)
    v_pk_add_f32 v[64:65], v[64:65], v[76:77]
    v_pk_add_f32 v[88:89], v[88:89], v[100:101]
    v_pk_add_f32 v[66:67], v[66:67], v[78:79]
    v_pk_add_f32 v[90:91], v[90:91], v[102:103]
    v_pk_add_f32 v[68:69], v[68:69], v[80:81]
    v_pk_add_f32 v[92:93], v[92:93], v[104:105]
    v_pk_add_f32 v[70:71], v[70:71], v[82:83]
    v_pk_add_f32 v[94:95], v[94:95], v[106:107]
    v_add_f32 v72, v72, v84
    v_add_f32 v96, v96, v108
    v_add_f32 v72, v72, v96
    v_pk_add_f32 v[64:65], v[64:65], v[88:89]
    v_pk_add_f32 v[66:67], v[66:67], v[90:91]
    v_pk_add_f32 v[68:69], v[68:69], v[92:93]
    v_pk_add_f32 v[70:71], v[70:71], v[94:95]
    v_cmp_le_f32 vcc, s36, v72
    s_nop 3
    s_and_b64 s[48:49], s[48:49], vcc
    v_cmp_ge_f32 vcc, s37, v72
    s_nop 3
    s_and_b64 s[48:49], s[48:49], vcc
    v_rcp_f32 v74, v72
    s_nop 0
    v_pk_mul_f32 v[64:65], v[64:65], v[74:75] op_sel_hi:[1,0]
    v_pk_mul_f32 v[66:67], v[66:67], v[74:75] op_sel_hi:[1,0]
    v_pk_mul_f32 v[68:69], v[68:69], v[74:75] op_sel_hi:[1,0]
    v_pk_mul_f32 v[70:71], v[70:71], v[74:75] op_sel_hi:[1,0]
    v_cvt_pk_bf16_f32 v24, v64, v65
    v_cvt_pk_bf16_f32 v25, v66, v67
    v_cvt_pk_bf16_f32 v26, v68, v69
    v_cvt_pk_bf16_f32 v27, v70, v71
    buffer_store_dwordx4 v[24:27], v3, s[8:11], s38 offen sc1
    s_waitcnt lgkmcnt(0)
    v_pk_add_f32 v[112:113], v[112:113], v[124:125]
    v_pk_add_f32 v[136:137], v[136:137], v[148:149]
    v_pk_add_f32 v[114:115], v[114:115], v[126:127]
    v_pk_add_f32 v[138:139], v[138:139], v[150:151]
    v_pk_add_f32 v[116:117], v[116:117], v[128:129]
    v_pk_add_f32 v[140:141], v[140:141], v[152:153]
    v_pk_add_f32 v[118:119], v[118:119], v[130:131]
    v_pk_add_f32 v[142:143], v[142:143], v[154:155]
    v_add_f32 v120, v120, v132
    v_add_f32 v144, v144, v156
    v_add_f32 v120, v120, v144
    v_pk_add_f32 v[112:113], v[112:113], v[136:137]
    v_pk_add_f32 v[114:115], v[114:115], v[138:139]
    v_pk_add_f32 v[116:117], v[116:117], v[140:141]
    v_pk_add_f32 v[118:119], v[118:119], v[142:143]
    v_cmp_le_f32 vcc, s36, v120
    s_nop 3
    s_and_b64 s[48:49], s[48:49], vcc
    v_cmp_ge_f32 vcc, s37, v120
    s_nop 3
    s_and_b64 s[48:49], s[48:49], vcc
    v_rcp_f32 v122, v120
    s_nop 0
    v_pk_mul_f32 v[112:113], v[112:113], v[122:123] op_sel_hi:[1,0]
    v_pk_mul_f32 v[114:115], v[114:115], v[122:123] op_sel_hi:[1,0]
    v_pk_mul_f32 v[116:117], v[116:117], v[122:123] op_sel_hi:[1,0]
    v_pk_mul_f32 v[118:119], v[118:119], v[122:123] op_sel_hi:[1,0]
    v_cvt_pk_bf16_f32 v28, v112, v113
    v_cvt_pk_bf16_f32 v29, v114, v115
    v_cvt_pk_bf16_f32 v30, v116, v117
    v_cvt_pk_bf16_f32 v31, v118, v119
    buffer_store_dwordx4 v[28:31], v3, s[8:11], s39 offen sc1
    s_waitcnt vmcnt(2)
    v_add_f32 v32, v32, v33
    v_add_f32 v34, v34, v35
    v_add_f32 v32, v32, v34
    v_cvt_pk_bf16_f32 v33, v32, v32
    v_and_b32 v33, 0xffff0000, v33
    v_sub_f32 v34, v32, v33
    v_cvt_pk_bf16_f32 v208, v33, v34
    v_mov_b32 v209, v208
    v_mov_b32 v210, 0
    v_mov_b32 v211, 0
    v_add_f32 v36, v36, v37
    v_add_f32 v38, v38, v39
    v_add_f32 v36, v36, v38
    v_cvt_pk_bf16_f32 v37, v36, v36
    v_and_b32 v37, 0xffff0000, v37
    v_sub_f32 v38, v36, v37
    v_cvt_pk_bf16_f32 v212, v37, v38
    v_mov_b32 v213, v212
    v_mov_b32 v214, 0
    v_mov_b32 v215, 0
    v_add_f32 v40, v40, v41
    v_add_f32 v42, v42, v43
    v_add_f32 v40, v40, v42
    v_cvt_pk_bf16_f32 v41, v40, v40
    v_and_b32 v41, 0xffff0000, v41
    v_sub_f32 v42, v40, v41
    v_cvt_pk_bf16_f32 v216, v41, v42
    v_mov_b32 v217, v216
    v_mov_b32 v218, 0
    v_mov_b32 v219, 0
    v_add_f32 v44, v44, v45
    v_add_f32 v46, v46, v47
    v_add_f32 v44, v44, v46
    v_cvt_pk_bf16_f32 v45, v44, v44
    v_and_b32 v45, 0xffff0000, v45
    v_sub_f32 v46, v44, v45
    v_cvt_pk_bf16_f32 v220, v45, v46
    v_mov_b32 v221, v220
    v_mov_b32 v222, 0
    v_mov_b32 v223, 0
    v_add_f32 v48, v48, v49
    v_add_f32 v50, v50, v51
    v_add_f32 v48, v48, v50
    v_cvt_pk_bf16_f32 v49, v48, v48
    v_and_b32 v49, 0xffff0000, v49
    v_sub_f32 v50, v48, v49
    v_cvt_pk_bf16_f32 v224, v49, v50
    v_mov_b32 v225, v224
    v_mov_b32 v226, 0
    v_mov_b32 v227, 0
    v_add_f32 v52, v52, v53
    v_add_f32 v54, v54, v55
    v_add_f32 v52, v52, v54
    v_cvt_pk_bf16_f32 v53, v52, v52
    v_and_b32 v53, 0xffff0000, v53
    v_sub_f32 v54, v52, v53
    v_cvt_pk_bf16_f32 v228, v53, v54
    v_mov_b32 v229, v228
    v_mov_b32 v230, 0
    v_mov_b32 v231, 0
    v_add_f32 v56, v56, v57
    v_add_f32 v58, v58, v59
    v_add_f32 v56, v56, v58
    v_cvt_pk_bf16_f32 v57, v56, v56
    v_and_b32 v57, 0xffff0000, v57
    v_sub_f32 v58, v56, v57
    v_cvt_pk_bf16_f32 v232, v57, v58
    v_mov_b32 v233, v232
    v_mov_b32 v234, 0
    v_mov_b32 v235, 0
    s_cmp_eq_u64 s[48:49], -1
    s_cselect_b32 s36, 0, 1
    v_mov_b32 v16, s36
    s_lshl_b32 s37, s20, 2
    v_mov_b32 v17, s37
    ds_write_b32 v17, v16
    s_waitcnt lgkmcnt(0)
    s_barrier
    v_mov_b32 v17, 0
    ds_read_b128 v[16:19], v17
    s_waitcnt lgkmcnt(0)
    v_or3_b32 v16, v16, v17, v18
    v_or_b32 v16, v16, v19
    s_nop 0
    v_readfirstlane_b32 s36, v16
    s_nop 3
    s_andn2_b32 s36, s36, s47
    s_cmp_lg_u32 s36, 0
    s_cbranch_scc1 mg_SLOW
    s_add_u32 s65, s64, 65536
    s_waitcnt vmcnt(0)
    s_lshl_b32 s62, s2, 7
    s_lshl_b32 s63, s20, 2
    s_add_u32 s62, s62, s63
    s_add_u32 s62, s62, s65
    v_mov_b32 v16, s6
    v_mov_b32 v17, 0
    s_mov_b64 exec, 1
    buffer_store_dword v16, v17, s[8:11], s62 offen sc1
    s_mov_b64 exec, -1
    s_add_u32 m0, s45, 65536
    s_nop 0
    buffer_load_dwordx4 v3, s[8:11], s44 offen offset:0 sc1 lds
    buffer_load_dwordx4 v3, s[8:11], s44 offen offset:1024 sc1 lds
    buffer_load_dwordx4 v3, s[8:11], s44 offen offset:2048 sc1 lds
    buffer_load_dwordx4 v3, s[8:11], s44 offen offset:3072 sc1 lds
    s_add_u32 s44, s44, 16384
    s_add_u32 m0, s45, 81920
    s_nop 0
    buffer_load_dwordx4 v3, s[8:11], s44 offen offset:0 sc1 lds
    buffer_load_dwordx4 v3, s[8:11], s44 offen offset:1024 sc1 lds
    buffer_load_dwordx4 v3, s[8:11], s44 offen offset:2048 sc1 lds
    buffer_load_dwordx4 v3, s[8:11], s44 offen offset:3072 sc1 lds
    s_add_u32 s44, s44, 16384
    s_lshr_b32 s33, s20, 1
    s_lshl_b32 s34, s23, 1
    s_add_u32 s33, s33, s34
    s_and_b32 s34, s20, 1
    s_lshl_b32 s35, s24, 1
    s_add_u32 s34, s34, s35
    s_lshl_b32 s35, s33, 5
    s_lshl_b32 s36, s34, 1
    s_add_u32 s35, s35, s36
    s_lshl_b32 s35, s35, 10
    s_add_u32 s36, s35, 0
    s_add_u32 s36, s36, s7
    buffer_load_dwordx4 v[8:11], v3, s[8:11], s36 offen sc1
    buffer_load_dwordx4 v[12:15], v3, s[8:11], s36 offen offset:1024 sc1
    s_mul_i32 s67, s24, 229376
    s_mul_i32 s43, s20, 28672
    s_add_u32 s67, s67, s43
    s_add_u32 s67, s67, 47710208
    s_mov_b32 s66, 0
    s_and_b32 s42, s20, 1
    s_mul_i32 s42, s42, 114688
    s_add_u32 s67, s67, s42
    s_add_u32 s42, s67, s66
    s_add_u32 s43, s42, s78
    s_lshl_b32 s28, s23, 16
    s_lshl_b32 s29, s20, 13
    s_add_u32 s28, s28, s29
    s_add_u32 s28, s28, 10485760
    s_add_u32 s28, s28, s7
    s_add_u32 s29, s28, 32768
    s_lshr_b32 s36, s20, 1
    s_lshl_b32 s36, s36, 15
    s_sub_u32 s29, s29, s36
    s_add_u32 s28, s28, s36
    s_add_u32 s65, s64, 65536
    s_cmp_eq_u32 s20, 0
    s_cbranch_scc0 mg_WD14
    s_mov_b32 s62, 20000
mg_W13:
    buffer_load_dword v16, v252, s[8:11], s65 offen sc1
    s_waitcnt vmcnt(0)
    v_cmp_ne_u32 vcc, s6, v16
    s_nop 3
    s_cbranch_vccz mg_WD14
    s_sub_u32 s62, s62, 1
    s_cmp_lg_u32 s62, 0
    s_cbranch_scc1 mg_W13
mg_WD14:
    s_waitcnt vmcnt(0)
    s_barrier
    buffer_load_dwordx4 a[0:3], v3, s[8:11], s28 offen offset:0 sc1
    buffer_load_dwordx4 a[4:7], v3, s[8:11], s29 offen offset:0 sc1
    buffer_load_dwordx4 a[8:11], v3, s[8:11], s28 offen offset:1024 sc1
    buffer_load_dwordx4 a[12:15], v3, s[8:11], s29 offen offset:1024 sc1
    buffer_load_dwordx4 a[16:19], v3, s[8:11], s28 offen offset:2048 sc1
    buffer_load_dwordx4 a[20:23], v3, s[8:11], s29 offen offset:2048 sc1
    buffer_load_dwordx4 a[24:27], v3, s[8:11], s28 offen offset:3072 sc1
    buffer_load_dwordx4 a[28:31], v3, s[8:11], s29 offen offset:3072 sc1
    s_add_u32 s28, s28, 4096
    s_add_u32 s29, s29, 4096
    buffer_load_dwordx4 a[32:35], v3, s[8:11], s28 offen offset:0 sc1
    buffer_load_dwordx4 a[36:39], v3, s[8:11], s29 offen offset:0 sc1
    buffer_load_dwordx4 a[40:43], v3, s[8:11], s28 offen offset:1024 sc1
    buffer_load_dwordx4 a[44:47], v3, s[8:11], s29 offen offset:1024 sc1
    buffer_load_dwordx4 a[48:51], v3, s[8:11], s28 offen offset:2048 sc1
    buffer_load_dwordx4 a[52:55], v3, s[8:11], s29 offen offset:2048 sc1
    buffer_load_dwordx4 a[56:59], v3, s[8:11], s28 offen offset:3072 sc1
    buffer_load_dwordx4 a[60:63], v3, s[8:11], s29 offen offset:3072 sc1
    s_waitcnt vmcnt(15)
    v_mfma_f32_32x32x16_bf16 v[64:79], a[192:195], a[0:3], 0
    v_mfma_f32_32x32x16_bf16 v[80:95], a[196:199], a[0:3], 0
    s_waitcnt vmcnt(14)
    v_mfma_f32_32x32x16_bf16 v[96:111], a[192:195], a[4:7], 0
    v_mfma_f32_32x32x16_bf16 v[112:127], a[196:199], a[4:7], 0
    s_waitcnt vmcnt(13)
    v_mfma_f32_32x32x16_bf16 v[64:79], a[200:203], a[8:11], v[64:79]
    v_mfma_f32_32x32x16_bf16 v[80:95], a[204:207], a[8:11], v[80:95]
    s_waitcnt vmcnt(12)
    v_mfma_f32_32x32x16_bf16 v[96:111], a[200:203], a[12:15], v[96:111]
    v_mfma_f32_32x32x16_bf16 v[112:127], a[204:207], a[12:15], v[112:127]
    s_waitcnt vmcnt(11)
    v_mfma_f32_32x32x16_bf16 v[64:79], a[208:211], a[16:19], v[64:79]
    v_mfma_f32_32x32x16_bf16 v[80:95], a[212:215], a[16:19], v[80:95]
    s_waitcnt vmcnt(10)
    v_mfma_f32_32x32x16_bf16 v[96:111], a[208:211], a[20:23], v[96:111]
    v_mfma_f32_32x32x16_bf16 v[112:127], a[212:215], a[20:23], v[112:127]
    s_waitcnt vmcnt(9)
    v_mfma_f32_32x32x16_bf16 v[64:79], a[216:219], a[24:27], v[64:79]
    v_mfma_f32_32x32x16_bf16 v[80:95], a[220:223], a[24:27], v[80:95]
    s_waitcnt vmcnt(8)
    v_mfma_f32_32x32x16_bf16 v[96:111], a[216:219], a[28:31], v[96:111]
    v_mfma_f32_32x32x16_bf16 v[112:127], a[220:223], a[28:31], v[112:127]
    s_waitcnt vmcnt(7)
    v_mfma_f32_32x32x16_bf16 v[64:79], a[224:227], a[32:35], v[64:79]
    v_mfma_f32_32x32x16_bf16 v[80:95], a[228:231], a[32:35], v[80:95]
    s_waitcnt vmcnt(6)
    v_mfma_f32_32x32x16_bf16 v[96:111], a[224:227], a[36:39], v[96:111]
    v_mfma_f32_32x32x16_bf16 v[112:127], a[228:231], a[36:39], v[112:127]
    s_waitcnt vmcnt(5)
    v_mfma_f32_32x32x16_bf16 v[64:79], a[232:235], a[40:43], v[64:79]
    v_mfma_f32_32x32x16_bf16 v[80:95], a[236:239], a[40:43], v[80:95]
    s_waitcnt vmcnt(4)
    v_mfma_f32_32x32x16_bf16 v[96:111], a[232:235], a[44:47], v[96:111]
    v_mfma_f32_32x32x16_bf16 v[112:127], a[236:239], a[44:47], v[112:127]
    s_waitcnt vmcnt(3)
    v_mfma_f32_32x32x16_bf16 v[64:79], a[240:243], a[48:51], v[64:79]
    v_mfma_f32_32x32x16_bf16 v[80:95], a[244:247], a[48:51], v[80:95]
    s_waitcnt vmcnt(2)
    v_mfma_f32_32x32x16_bf16 v[96:111], a[240:243], a[52:55], v[96:111]
    v_mfma_f32_32x32x16_bf16 v[112:127], a[244:247], a[52:55], v[112:127]
    s_waitcnt vmcnt(1)
    v_mfma_f32_32x32x16_bf16 v[64:79], a[248:251], a[56:59], v[64:79]
    v_mfma_f32_32x32x16_bf16 v[80:95], a[252:255], a[56:59], v[80:95]
    s_waitcnt vmcnt(0)
    v_mfma_f32_32x32x16_bf16 v[96:111], a[248:251], a[60:63], v[96:111]
    v_mfma_f32_32x32x16_bf16 v[112:127], a[252:255], a[60:63], v[112:127]
    s_xor_b32 s37, s20, 1
    s_lshl_b32 s37, s37, 14
    v_add_u32 v28, s37, v3
    s_xor_b32 s37, s20, 2
    s_lshl_b32 s37, s37, 14
    v_add_u32 v29, s37, v3
    s_xor_b32 s37, s20, 3
    s_lshl_b32 s37, s37, 14
    v_add_u32 v30, s37, v3
    ds_write_b128 v28, v[80:83] offset:4096
    ds_write_b128 v28, v[84:87] offset:5120
    ds_write_b128 v28, v[88:91] offset:6144
    ds_write_b128 v28, v[92:95] offset:7168
    ds_write_b128 v29, v[96:99] offset:8192
    ds_write_b128 v29, v[100:103] offset:9216
    ds_write_b128 v29, v[104:107] offset:10240
    ds_write_b128 v29, v[108:111] offset:11264
    ds_write_b128 v30, v[112:115] offset:12288
    ds_write_b128 v30, v[116:119] offset:13312
    ds_write_b128 v30, v[120:123] offset:14336
    ds_write_b128 v30, v[124:127] offset:15360
    s_lshl_b32 s37, s20, 14
    v_add_u32 v7, s37, v3
    v_lshlrev_b32 v32, 16, v8
    v_and_b32 v33, 0xffff0000, v8
    v_lshlrev_b32 v34, 16, v9
    v_and_b32 v35, 0xffff0000, v9
    v_lshlrev_b32 v36, 16, v10
    v_and_b32 v37, 0xffff0000, v10
    v_lshlrev_b32 v38, 16, v11
    v_and_b32 v39, 0xffff0000, v11
    v_lshlrev_b32 v40, 16, v12
    v_and_b32 v41, 0xffff0000, v12
    v_lshlrev_b32 v42, 16, v13
    v_and_b32 v43, 0xffff0000, v13
    v_lshlrev_b32 v44, 16, v14
    v_and_b32 v45, 0xffff0000, v14
    v_lshlrev_b32 v46, 16, v15
    v_and_b32 v47, 0xffff0000, v15
    v_pk_add_f32 v[64:65], v[64:65], v[32:33]
    v_pk_add_f32 v[66:67], v[66:67], v[34:35]
    v_pk_add_f32 v[68:69], v[68:69], v[36:37]
    v_pk_add_f32 v[70:71], v[70:71], v[38:39]
    v_pk_add_f32 v[72:73], v[72:73], v[40:41]
    v_pk_add_f32 v[74:75], v[74:75], v[42:43]
    v_pk_add_f32 v[76:77], v[76:77], v[44:45]
    v_pk_add_f32 v[78:79], v[78:79], v[46:47]
    s_waitcnt lgkmcnt(0)
    s_barrier
    ds_read_b128 v[144:147], v7 offset:4096
    ds_read_b128 v[148:151], v7 offset:5120
    ds_read_b128 v[152:155], v7 offset:6144
    ds_read_b128 v[156:159], v7 offset:7168
    ds_read_b128 v[160:163], v7 offset:8192
    ds_read_b128 v[164:167], v7 offset:9216
    ds_read_b128 v[168:171], v7 offset:10240
    ds_read_b128 v[172:175], v7 offset:11264
    ds_read_b128 v[176:179], v7 offset:12288
    ds_read_b128 v[180:183], v7 offset:13312
    ds_read_b128 v[184:187], v7 offset:14336
    ds_read_b128 v[188:191], v7 offset:15360
    s_waitcnt lgkmcnt(8)
    v_pk_add_f32 v[64:65], v[64:65], v[144:145]
    v_pk_add_f32 v[66:67], v[66:67], v[146:147]
    v_pk_add_f32 v[68:69], v[68:69], v[148:149]
    v_pk_add_f32 v[70:71], v[70:71], v[150:151]
    v_pk_add_f32 v[72:73], v[72:73], v[152:153]
    v_pk_add_f32 v[74:75], v[74:75], v[154:155]
    v_pk_add_f32 v[76:77], v[76:77], v[156:157]
    v_pk_add_f32 v[78:79], v[78:79], v[158:159]
    s_waitcnt lgkmcnt(0)
    v_pk_add_f32 v[160:161], v[160:161], v[176:177]
    v_pk_add_f32 v[162:163], v[162:163], v[178:179]
    v_pk_add_f32 v[164:165], v[164:165], v[180:181]
    v_pk_add_f32 v[166:167], v[166:167], v[182:183]
    v_pk_add_f32 v[168:169], v[168:169], v[184:185]
    v_pk_add_f32 v[170:171], v[170:171], v[186:187]
    v_pk_add_f32 v[172:173], v[172:173], v[188:189]
    v_pk_add_f32 v[174:175], v[174:175], v[190:191]
    v_pk_add_f32 v[64:65], v[64:65], v[160:161]
    v_pk_add_f32 v[66:67], v[66:67], v[162:163]
    v_pk_add_f32 v[68:69], v[68:69], v[164:165]
    v_pk_add_f32 v[70:71], v[70:71], v[166:167]
    v_pk_add_f32 v[72:73], v[72:73], v[168:169]
    v_pk_add_f32 v[74:75], v[74:75], v[170:171]
    v_pk_add_f32 v[76:77], v[76:77], v[172:173]
    v_pk_add_f32 v[78:79], v[78:79], v[174:175]
    v_cvt_pk_bf16_f32 v16, v64, v65
    v_cvt_pk_bf16_f32 v17, v66, v67
    v_cvt_pk_bf16_f32 v18, v68, v69
    v_cvt_pk_bf16_f32 v19, v70, v71
    v_cvt_pk_bf16_f32 v20, v72, v73
    v_cvt_pk_bf16_f32 v21, v74, v75
    v_cvt_pk_bf16_f32 v22, v76, v77
    v_cvt_pk_bf16_f32 v23, v78, v79
    s_add_u32 s36, s35, 2097152
    s_add_u32 s36, s36, s7
    buffer_store_dwordx4 v[16:19], v3, s[8:11], s36 offen sc1
    buffer_store_dwordx4 v[20:23], v3, s[8:11], s36 offen offset:1024 sc1
    s_mov_b32 s37, 0x3f803f80
    v_mov_b32 v6, 0
    v_mov_b32 v7, 0
    v_dot2c_f32_bf16 v6, s37, v16
    v_dot2c_f32_bf16 v7, v16, v16
    v_dot2c_f32_bf16 v6, s37, v17
    v_dot2c_f32_bf16 v7, v17, v17
    v_dot2c_f32_bf16 v6, s37, v18
    v_dot2c_f32_bf16 v7, v18, v18
    v_dot2c_f32_bf16 v6, s37, v19
    v_dot2c_f32_bf16 v7, v19, v19
    v_dot2c_f32_bf16 v6, s37, v20
    v_dot2c_f32_bf16 v7, v20, v20
    v_dot2c_f32_bf16 v6, s37, v21
    v_dot2c_f32_bf16 v7, v21, v21
    v_dot2c_f32_bf16 v6, s37, v22
    v_dot2c_f32_bf16 v7, v22, v22
    v_dot2c_f32_bf16 v6, s37, v23
    v_dot2c_f32_bf16 v7, v23, v23
    s_nop 2
    v_permlane32_swap_b32 v6, v7
    v_add_f32 v6, v6, v7
    s_lshr_b32 s38, s34, 1
    s_lshl_b32 s38, s38, 15
    s_lshl_b32 s39, s33, 9
    s_add_u32 s38, s38, s39
    s_and_b32 s39, s34, 1
    s_lshl_b32 s39, s39, 3
    s_add_u32 s38, s38, s39
    s_add_u32 s38, s38, 12845056
    s_add_u32 s38, s38, s7
    v_lshlrev_b32 v8, 4, v4
    v_lshl_add_u32 v8, v5, 2, v8
    buffer_store_dword v6, v8, s[8:11], s38 offen sc1
    s_add_u32 s65, s64, 98304
    s_waitcnt vmcnt(0)
    s_lshl_b32 s62, s2, 7
    s_lshl_b32 s63, s20, 2
    s_add_u32 s62, s62, s63
    s_add_u32 s62, s62, s65
    v_mov_b32 v16, s6
    v_mov_b32 v17, 0
    s_mov_b64 exec, 1
    buffer_store_dword v16, v17, s[8:11], s62 offen sc1
    s_mov_b64 exec, -1
    s_barrier
    s_mul_i32 s30, s22, 229376
    s_lshl_b32 s31, s20, 12
    s_add_u32 s30, s30, s31
    s_add_u32 s30, s30, 43614208
    s_add_u32 m0, s31, 0
    s_nop 0
    buffer_load_dwordx4 v3, s[8:11], s30 offen offset:0 sc1 lds
    buffer_load_dwordx4 v3, s[8:11], s30 offen offset:1024 sc1 lds
    buffer_load_dwordx4 v3, s[8:11], s30 offen offset:2048 sc1 lds
    buffer_load_dwordx4 v3, s[8:11], s30 offen offset:3072 sc1 lds
    s_add_u32 s30, s30, 16384
    s_add_u32 m0, s31, 16384
    s_nop 0
    buffer_load_dwordx4 v3, s[8:11], s30 offen offset:0 sc1 lds
    buffer_load_dwordx4 v3, s[8:11], s30 offen offset:1024 sc1 lds
    buffer_load_dwordx4 v3, s[8:11], s30 offen offset:2048 sc1 lds
    buffer_load_dwordx4 v3, s[8:11], s30 offen offset:3072 sc1 lds
    s_add_u32 s30, s30, 16384
    s_add_u32 m0, s31, 32768
    s_nop 0
    buffer_load_dwordx4 v3, s[8:11], s30 offen offset:0 sc1 lds
    buffer_load_dwordx4 v3, s[8:11], s30 offen offset:1024 sc1 lds
    buffer_load_dwordx4 v3, s[8:11], s30 offen offset:2048 sc1 lds
    buffer_load_dwordx4 v3, s[8:11], s30 offen offset:3072 sc1 lds
    s_add_u32 s30, s30, 16384
    s_add_u32 m0, s31, 49152
    s_nop 0
    buffer_load_dwordx4 v3, s[8:11], s30 offen offset:0 sc1 lds
    buffer_load_dwordx4 v3, s[8:11], s30 offen offset:1024 sc1 lds
    buffer_load_dwordx4 v3, s[8:11], s30 offen offset:2048 sc1 lds
    buffer_load_dwordx4 v3, s[8:11], s30 offen offset:3072 sc1 lds
    s_add_u32 s30, s30, 16384
    s_lshl_b32 s27, s21, 2
    s_add_u32 s27, s27, s20
    s_add_u32 s65, s64, 98304
    v_add_u32 v8, 49152, v3
    v_add_u32 v9, 0x18000, v3
    v_add_u32 v10, 0x24000, v3
    s_mul_i32 s34, s27, 112
    s_mul_i32 s35, s22, 7
    s_add_u32 s34, s34, s35
    s_lshl_b32 s34, s34, 10
    s_add_u32 s34, s34, 13631488
    s_add_u32 s34, s34, s7
    s_add_u32 s35, s34, 4096
    s_lshl_b32 s32, s27, 15
    s_add_u32 s32, s32, 2097152
    s_add_u32 s32, s32, s7
    ds_read_b128 v[176:179], v9 offset:0
    ds_read_b128 v[180:183], v9 offset:1024
    ds_read_b128 v[184:187], v9 offset:2048
    ds_read_b128 v[188:191], v9 offset:3072
    ds_read_b128 v[192:195], v9 offset:4096
    ds_read_b128 v[196:199], v9 offset:5120
    s_cmp_eq_u32 s20, 0
    s_cbranch_scc0 mg_WD16
    s_mov_b32 s62, 20000
mg_W15:
    buffer_load_dword v16, v250, s[8:11], s65 offen sc1
    s_waitcnt vmcnt(0)
    v_cmp_ne_u32 vcc, s6, v16
    s_nop 3
    s_cbranch_vccz mg_WD16
    s_sub_u32 s62, s62, 1
    s_cmp_lg_u32 s62, 0
    s_cbranch_scc1 mg_W15
mg_WD16:
    s_waitcnt vmcnt(0)
    s_barrier
    buffer_load_dwordx4 a[0:3], v3, s[8:11], s32 offen offset:0 sc1
    buffer_load_dwordx4 a[4:7], v3, s[8:11], s32 offen offset:1024 sc1
    v_lshlrev_b32 v6, 4, v4
    v_lshl_add_u32 v6, v5, 17, v6
    s_lshl_b32 s28, s27, 9
    s_add_u32 s28, s28, 12845056
    s_add_u32 s28, s28, s7
    buffer_load_dwordx4 v[16:19], v6, s[8:11], s28 offen sc1
    s_add_u32 s28, s28, 32768
    buffer_load_dwordx4 v[20:23], v6, s[8:11], s28 offen sc1
    s_add_u32 s28, s28, 32768
    buffer_load_dwordx4 v[24:27], v6, s[8:11], s28 offen sc1
    s_add_u32 s28, s28, 32768
    buffer_load_dwordx4 v[28:31], v6, s[8:11], s28 offen sc1
    buffer_load_dwordx4 a[8:11], v3, s[8:11], s32 offen offset:2048 sc1
    buffer_load_dwordx4 a[12:15], v3, s[8:11], s32 offen offset:3072 sc1
    s_add_u32 s32, s32, 4096
    buffer_load_dwordx4 a[16:19], v3, s[8:11], s32 offen offset:0 sc1
    buffer_load_dwordx4 a[20:23], v3, s[8:11], s32 offen offset:1024 sc1
    s_waitcnt vmcnt(9)
    s_waitcnt lgkmcnt(4)
    v_mfma_f32_32x32x16_bf16 v[64:79], v[176:179], a[0:3], 0
    ds_read_b128 v[200:203], v9 offset:6144
    buffer_load_dwordx4 a[24:27], v3, s[8:11], s32 offen offset:2048 sc1
    v_mfma_f32_32x32x16_bf16 v[80:95], v[180:183], a[0:3], 0
    ds_read_b128 v[204:207], v9 offset:7168
    buffer_load_dwordx4 a[28:31], v3, s[8:11], s32 offen offset:3072 sc1
    s_add_u32 s32, s32, 4096
    s_waitcnt vmcnt(6)
    v_add_f32 v16, v16, v18
    v_add_f32 v17, v17, v19
    s_waitcnt lgkmcnt(4)
    v_mfma_f32_32x32x16_bf16 v[96:111], v[184:187], a[0:3], 0
    ds_read_b128 v[176:179], v9 offset:8192
    buffer_load_dwordx4 a[32:35], v3, s[8:11], s32 offen offset:0 sc1
    v_add_f32 v20, v20, v22
    v_add_f32 v21, v21, v23
    v_mfma_f32_32x32x16_bf16 v[64:79], v[188:191], a[4:7], v[64:79]
    ds_read_b128 v[180:183], v9 offset:9216
    buffer_load_dwordx4 a[36:39], v3, s[8:11], s32 offen offset:1024 sc1
    v_add_f32 v24, v24, v26
    v_add_f32 v25, v25, v27
    v_add_f32 v28, v28, v30
    s_waitcnt lgkmcnt(4)
    v_mfma_f32_32x32x16_bf16 v[80:95], v[192:195], a[4:7], v[80:95]
    ds_read_b128 v[184:187], v9 offset:10240
    buffer_load_dwordx4 a[40:43], v3, s[8:11], s32 offen offset:2048 sc1
    v_add_f32 v29, v29, v31
    v_add_f32 v16, v16, v20
    v_add_f32 v17, v17, v21
    v_mfma_f32_32x32x16_bf16 v[96:111], v[196:199], a[4:7], v[96:111]
    ds_read_b128 v[188:191], v9 offset:11264
    buffer_load_dwordx4 a[44:47], v3, s[8:11], s32 offen offset:3072 sc1
    s_add_u32 s32, s32, 4096
    v_add_f32 v24, v24, v28
    v_add_f32 v25, v25, v29
    v_add_f32 v16, v16, v24
    s_waitcnt vmcnt(9)
    s_waitcnt lgkmcnt(4)
    v_mfma_f32_32x32x16_bf16 v[64:79], v[200:203], a[8:11], v[64:79]
    ds_read_b128 v[192:195], v9 offset:12288
    buffer_load_dwordx4 a[48:51], v3, s[8:11], s32 offen offset:0 sc1
    v_add_f32 v17, v17, v25
    v_mov_b32 v18, v16
    v_mfma_f32_32x32x16_bf16 v[80:95], v[204:207], a[8:11], v[80:95]
    ds_read_b128 v[196:199], v9 offset:13312
    buffer_load_dwordx4 a[52:55], v3, s[8:11], s32 offen offset:1024 sc1
    v_mov_b32 v19, v17
    v_permlane32_swap_b32 v16, v18
    s_nop 0
    v_permlane32_swap_b32 v17, v19
    s_waitcnt lgkmcnt(4)
    v_mfma_f32_32x32x16_bf16 v[96:111], v[176:179], a[8:11], v[96:111]
    ds_read_b128 v[200:203], v9 offset:14336
    buffer_load_dwordx4 a[56:59], v3, s[8:11], s32 offen offset:2048 sc1
    v_add_f32 v16, v16, v18
    v_add_f32 v17, v17, v19
    v_mul_f32 v16, 0x3b000000, v16
    s_waitcnt vmcnt(11)
    v_mfma_f32_32x32x16_bf16 v[64:79], v[180:183], a[12:15], v[64:79]
    ds_read_b128 v[204:207], v9 offset:15360
    buffer_load_dwordx4 a[60:63], v3, s[8:11], s32 offen offset:3072 sc1
    s_add_u32 s32, s32, 4096
    v_mul_f32 v17, 0x3b000000, v17
    v_fma_f32 v17, -v16, v16, v17
    v_max_f32 v17, 0, v17
    s_waitcnt lgkmcnt(4)
    v_mfma_f32_32x32x16_bf16 v[80:95], v[184:187], a[12:15], v[80:95]
    ds_read_b128 v[176:179], v9 offset:16384
    buffer_load_dwordx4 a[64:67], v3, s[8:11], s32 offen offset:0 sc1
    v_add_f32 v17, 0x3727c5ac, v17
    v_mfma_f32_32x32x16_bf16 v[96:111], v[188:191], a[12:15], v[96:111]
    ds_read_b128 v[180:183], v9 offset:17408
    buffer_load_dwordx4 a[68:71], v3, s[8:11], s32 offen offset:1024 sc1
    v_rsq_f32 v60, v17
    v_sub_f32 v18, 0, v16
    v_cvt_pk_bf16_f32 v56, v18, v18
    s_waitcnt vmcnt(13)
    s_waitcnt lgkmcnt(4)
    v_mfma_f32_32x32x16_bf16 v[64:79], v[192:195], a[16:19], v[64:79]
    ds_read_b128 v[184:187], v9 offset:18432
    buffer_load_dwordx4 a[72:75], v3, s[8:11], s32 offen offset:2048 sc1
    v_and_b32 v19, 0xffff0000, v56
    v_sub_f32 v19, v18, v19
    v_cvt_pk_bf16_f32 v57, v19, v19
    v_mfma_f32_32x32x16_bf16 v[80:95], v[196:199], a[16:19], v[80:95]
    ds_read_b128 v[188:191], v9 offset:19456
    buffer_load_dwordx4 a[76:79], v3, s[8:11], s32 offen offset:3072 sc1
    s_add_u32 s32, s32, 4096
    v_mul_f32 v61, v17, v60
    v_cmp_gt_u32 vcc, 32, v1
    v_mov_b32 v58, 0
    s_waitcnt lgkmcnt(4)
    v_mfma_f32_32x32x16_bf16 v[96:111], v[200:203], a[16:19], v[96:111]
    ds_read_b128 v[192:195], v9 offset:20480
    buffer_load_dwordx4 a[80:83], v3, s[8:11], s32 offen offset:0 sc1
    v_mov_b32 v59, 0
    v_cndmask_b32 v56, 0, v56, vcc
    s_waitcnt vmcnt(15)
    v_mfma_f32_32x32x16_bf16 v[64:79], v[204:207], a[20:23], v[64:79]
    ds_read_b128 v[196:199], v9 offset:21504
    buffer_load_dwordx4 a[84:87], v3, s[8:11], s32 offen offset:1024 sc1
    v_cndmask_b32 v57, 0, v57, vcc
    v_mul_f32 v62, 0xbfb8aa3b, v60
    s_waitcnt lgkmcnt(4)
    v_mfma_f32_32x32x16_bf16 v[80:95], v[176:179], a[20:23], v[80:95]
    ds_read_b128 v[200:203], v9 offset:22528
    buffer_load_dwordx4 a[88:91], v3, s[8:11], s32 offen offset:2048 sc1
    v_mfma_f32_32x32x16_bf16 v[96:111], v[180:183], a[20:23], v[96:111]
    ds_read_b128 v[204:207], v9 offset:23552
    buffer_load_dwordx4 a[92:95], v3, s[8:11], s32 offen offset:3072 sc1
    s_add_u32 s32, s32, 4096
    s_waitcnt vmcnt(17)
    s_waitcnt lgkmcnt(4)
    v_mfma_f32_32x32x16_bf16 v[64:79], v[184:187], a[24:27], v[64:79]
    ds_read_b128 v[176:179], v9 offset:24576
    buffer_load_dwordx4 a[96:99], v3, s[8:11], s32 offen offset:0 sc1
    v_mfma_f32_32x32x16_bf16 v[80:95], v[188:191], a[24:27], v[80:95]
    ds_read_b128 v[180:183], v9 offset:25600
    buffer_load_dwordx4 a[100:103], v3, s[8:11], s32 offen offset:1024 sc1
    s_waitcnt lgkmcnt(4)
    v_mfma_f32_32x32x16_bf16 v[96:111], v[192:195], a[24:27], v[96:111]
    ds_read_b128 v[184:187], v9 offset:26624
    v_mfma_f32_32x32x16_bf16 v[64:79], v[208:211], v[56:59], v[64:79]
    buffer_load_dwordx4 a[104:107], v3, s[8:11], s32 offen offset:2048 sc1
    v_mfma_f32_32x32x16_bf16 v[80:95], v[212:215], v[56:59], v[80:95]
    buffer_load_dwordx4 a[108:111], v3, s[8:11], s32 offen offset:3072 sc1
    s_add_u32 s32, s32, 4096
    v_mfma_f32_32x32x16_bf16 v[96:111], v[216:219], v[56:59], v[96:111]
    buffer_load_dwordx4 a[112:115], v3, s[8:11], s32 offen offset:0 sc1
    v_mfma_f32_32x32x16_bf16 v[112:127], v[220:223], v[56:59], 0
    buffer_load_dwordx4 a[116:119], v3, s[8:11], s32 offen offset:1024 sc1
    v_mfma_f32_32x32x16_bf16 v[128:143], v[224:227], v[56:59], 0
    buffer_load_dwordx4 a[120:123], v3, s[8:11], s32 offen offset:2048 sc1
    v_mfma_f32_32x32x16_bf16 v[144:159], v[228:231], v[56:59], 0
    buffer_load_dwordx4 a[124:127], v3, s[8:11], s32 offen offset:3072 sc1
    v_mfma_f32_32x32x16_bf16 v[160:175], v[232:235], v[56:59], 0
    s_waitcnt vmcnt(24)
    v_mfma_f32_32x32x16_bf16 v[64:79], v[196:199], a[28:31], v[64:79]
    ds_read_b128 v[188:191], v9 offset:27648
    s_waitcnt lgkmcnt(4)
    v_mfma_f32_32x32x16_bf16 v[80:95], v[200:203], a[28:31], v[80:95]
    ds_read_b128 v[192:195], v9 offset:28672
    v_mfma_f32_32x32x16_bf16 v[96:111], v[204:207], a[28:31], v[96:111]
    ds_read_b128 v[196:199], v9 offset:29696
    s_waitcnt vmcnt(23)
    s_waitcnt lgkmcnt(4)
    v_mfma_f32_32x32x16_bf16 v[64:79], v[176:179], a[32:35], v[64:79]
    ds_read_b128 v[200:203], v9 offset:30720
    v_mfma_f32_32x32x16_bf16 v[80:95], v[180:183], a[32:35], v[80:95]
    ds_read_b128 v[204:207], v9 offset:31744
    s_waitcnt lgkmcnt(4)
    v_mfma_f32_32x32x16_bf16 v[96:111], v[184:187], a[32:35], v[96:111]
    ds_read_b128 v[176:179], v9 offset:32768
    s_waitcnt vmcnt(22)
    v_mfma_f32_32x32x16_bf16 v[64:79], v[188:191], a[36:39], v[64:79]
    ds_read_b128 v[180:183], v9 offset:33792
    s_waitcnt lgkmcnt(4)
    v_mfma_f32_32x32x16_bf16 v[80:95], v[192:195], a[36:39], v[80:95]
    ds_read_b128 v[184:187], v9 offset:34816
    v_mfma_f32_32x32x16_bf16 v[96:111], v[196:199], a[36:39], v[96:111]
    ds_read_b128 v[188:191], v9 offset:35840
    s_waitcnt vmcnt(21)
    s_waitcnt lgkmcnt(4)
    v_mfma_f32_32x32x16_bf16 v[64:79], v[200:203], a[40:43], v[64:79]
    ds_read_b128 v[192:195], v9 offset:36864
    v_mfma_f32_32x32x16_bf16 v[80:95], v[204:207], a[40:43], v[80:95]
    ds_read_b128 v[196:199], v9 offset:37888
    s_waitcnt lgkmcnt(4)
    v_mfma_f32_32x32x16_bf16 v[96:111], v[176:179], a[40:43], v[96:111]
    ds_read_b128 v[200:203], v9 offset:38912
    s_waitcnt vmcnt(20)
    v_mfma_f32_32x32x16_bf16 v[64:79], v[180:183], a[44:47], v[64:79]
    ds_read_b128 v[204:207], v9 offset:39936
    s_waitcnt lgkmcnt(4)
    v_mfma_f32_32x32x16_bf16 v[80:95], v[184:187], a[44:47], v[80:95]
    ds_read_b128 v[176:179], v9 offset:40960
    v_mfma_f32_32x32x16_bf16 v[96:111], v[188:191], a[44:47], v[96:111]
    ds_read_b128 v[180:183], v9 offset:41984
    s_waitcnt vmcnt(19)
    s_waitcnt lgkmcnt(4)
    v_mfma_f32_32x32x16_bf16 v[64:79], v[192:195], a[48:51], v[64:79]
    ds_read_b128 v[184:187], v9 offset:43008
    v_mfma_f32_32x32x16_bf16 v[80:95], v[196:199], a[48:51], v[80:95]
    ds_read_b128 v[188:191], v9 offset:44032
    s_waitcnt lgkmcnt(4)
    v_mfma_f32_32x32x16_bf16 v[96:111], v[200:203], a[48:51], v[96:111]
    ds_read_b128 v[192:195], v9 offset:45056
    s_waitcnt vmcnt(18)
    v_mfma_f32_32x32x16_bf16 v[64:79], v[204:207], a[52:55], v[64:79]
    ds_read_b128 v[196:199], v9 offset:46080
    s_waitcnt lgkmcnt(4)
    v_mfma_f32_32x32x16_bf16 v[80:95], v[176:179], a[52:55], v[80:95]
    ds_read_b128 v[200:203], v9 offset:47104
    v_mfma_f32_32x32x16_bf16 v[96:111], v[180:183], a[52:55], v[96:111]
    ds_read_b128 v[204:207], v9 offset:48128
    s_waitcnt vmcnt(17)
    s_waitcnt lgkmcnt(4)
    v_mfma_f32_32x32x16_bf16 v[64:79], v[184:187], a[56:59], v[64:79]
    ds_read_b128 v[176:179], v10 offset:0
    v_mfma_f32_32x32x16_bf16 v[80:95], v[188:191], a[56:59], v[80:95]
    ds_read_b128 v[180:183], v10 offset:1024
    s_waitcnt lgkmcnt(4)
    v_mfma_f32_32x32x16_bf16 v[96:111], v[192:195], a[56:59], v[96:111]
    ds_read_b128 v[184:187], v10 offset:2048
    s_waitcnt vmcnt(16)
    v_mfma_f32_32x32x16_bf16 v[64:79], v[196:199], a[60:63], v[64:79]
    ds_read_b128 v[188:191], v10 offset:3072
    s_waitcnt lgkmcnt(4)
    v_mfma_f32_32x32x16_bf16 v[80:95], v[200:203], a[60:63], v[80:95]
    ds_read_b128 v[192:195], v10 offset:4096
    v_mfma_f32_32x32x16_bf16 v[96:111], v[204:207], a[60:63], v[96:111]
    ds_read_b128 v[196:199], v10 offset:5120
    s_waitcnt vmcnt(15)
    s_waitcnt lgkmcnt(4)
    v_mfma_f32_32x32x16_bf16 v[64:79], v[176:179], a[64:67], v[64:79]
    ds_read_b128 v[200:203], v10 offset:6144
    v_mfma_f32_32x32x16_bf16 v[80:95], v[180:183], a[64:67], v[80:95]
    ds_read_b128 v[204:207], v10 offset:7168
    s_waitcnt lgkmcnt(4)
    v_mfma_f32_32x32x16_bf16 v[96:111], v[184:187], a[64:67], v[96:111]
    ds_read_b128 v[176:179], v10 offset:8192
    buffer_load_dwordx4 a[128:131], v3, s[8:11], s42 offen offset:0 sc1
    s_waitcnt vmcnt(15)
    v_mfma_f32_32x32x16_bf16 v[64:79], v[188:191], a[68:71], v[64:79]
    ds_read_b128 v[180:183], v10 offset:9216
    buffer_load_dwordx4 a[132:135], v3, s[8:11], s43 offen offset:0 sc1
    s_waitcnt lgkmcnt(4)
    v_mfma_f32_32x32x16_bf16 v[80:95], v[192:195], a[68:71], v[80:95]
    ds_read_b128 v[184:187], v10 offset:10240
    buffer_load_dwordx4 a[136:139], v3, s[8:11], s42 offen offset:1024 sc1
    v_mfma_f32_32x32x16_bf16 v[96:111], v[196:199], a[68:71], v[96:111]
    ds_read_b128 v[188:191], v10 offset:11264
    buffer_load_dwordx4 a[140:143], v3, s[8:11], s43 offen offset:1024 sc1
    s_waitcnt vmcnt(17)
    s_waitcnt lgkmcnt(4)
    v_mfma_f32_32x32x16_bf16 v[64:79], v[200:203], a[72:75], v[64:79]
    ds_read_b128 v[192:195], v10 offset:12288
    buffer_load_dwordx4 a[144:147], v3, s[8:11], s42 offen offset:2048 sc1
    v_mfma_f32_32x32x16_bf16 v[80:95], v[204:207], a[72:75], v[80:95]
    ds_read_b128 v[196:199], v10 offset:13312
    buffer_load_dwordx4 a[148:151], v3, s[8:11], s43 offen offset:2048 sc1
    s_waitcnt lgkmcnt(4)
    v_mfma_f32_32x32x16_bf16 v[96:111], v[176:179], a[72:75], v[96:111]
    ds_read_b128 v[200:203], v10 offset:14336
    buffer_load_dwordx4 a[152:155], v3, s[8:11], s42 offen offset:3072 sc1
    s_waitcnt vmcnt(19)
    v_mfma_f32_32x32x16_bf16 v[64:79], v[180:183], a[76:79], v[64:79]
    ds_read_b128 v[204:207], v10 offset:15360
    buffer_load_dwordx4 a[156:159], v3, s[8:11], s43 offen offset:3072 sc1
    s_waitcnt lgkmcnt(4)
    v_mfma_f32_32x32x16_bf16 v[80:95], v[184:187], a[76:79], v[80:95]
    ds_read_b128 v[176:179], v8 offset:16384
    s_add_u32 s66, s66, 4096
    s_cmp_ge_u32 s66, 28672
    s_cselect_b32 s68, 28672, 0
    s_sub_u32 s66, s66, s68
    s_add_u32 s42, s67, s66
    s_add_u32 s43, s42, s78
    buffer_load_dwordx4 a[160:163], v3, s[8:11], s42 offen offset:0 sc1
    v_mfma_f32_32x32x16_bf16 v[96:111], v[188:191], a[76:79], v[96:111]
    ds_read_b128 v[180:183], v8 offset:17408
    buffer_load_dwordx4 a[164:167], v3, s[8:11], s43 offen offset:0 sc1
    s_waitcnt vmcnt(21)
    s_waitcnt lgkmcnt(4)
    v_mfma_f32_32x32x16_bf16 v[64:79], v[192:195], a[80:83], v[64:79]
    ds_read_b128 v[184:187], v8 offset:18432
    buffer_load_dwordx4 a[168:171], v3, s[8:11], s42 offen offset:1024 sc1
    v_mfma_f32_32x32x16_bf16 v[80:95], v[196:199], a[80:83], v[80:95]
    ds_read_b128 v[188:191], v8 offset:19456
    buffer_load_dwordx4 a[172:175], v3, s[8:11], s43 offen offset:1024 sc1
    s_waitcnt lgkmcnt(4)
    v_mfma_f32_32x32x16_bf16 v[96:111], v[200:203], a[80:83], v[96:111]
    ds_read_b128 v[192:195], v8 offset:20480
    buffer_load_dwordx4 a[176:179], v3, s[8:11], s42 offen offset:2048 sc1
    s_waitcnt vmcnt(23)
    v_mfma_f32_32x32x16_bf16 v[64:79], v[204:207], a[84:87], v[64:79]
    ds_read_b128 v[196:199], v8 offset:21504
    buffer_load_dwordx4 a[180:183], v3, s[8:11], s43 offen offset:2048 sc1
    s_waitcnt lgkmcnt(4)
    v_mfma_f32_32x32x16_bf16 v[80:95], v[176:179], a[84:87], v[80:95]
    ds_read_b128 v[200:203], v8 offset:22528
    s_barrier
    buffer_load_dwordx4 a[184:187], v3, s[8:11], s42 offen offset:3072 sc1
    v_mfma_f32_32x32x16_bf16 v[96:111], v[180:183], a[84:87], v[96:111]
    ds_read_b128 v[204:207], v8 offset:23552
    buffer_load_dwordx4 a[188:191], v3, s[8:11], s43 offen offset:3072 sc1
    s_waitcnt vmcnt(25)
    s_waitcnt lgkmcnt(4)
    v_mfma_f32_32x32x16_bf16 v[64:79], v[184:187], a[88:91], v[64:79]
    ds_read_b128 v[176:179], v8 offset:24576
    s_add_u32 m0, s31, 98304
    s_nop 0
    buffer_load_dwordx4 v3, s[8:11], s30 offen offset:0 sc1 lds
    v_mfma_f32_32x32x16_bf16 v[80:95], v[188:191], a[88:91], v[80:95]
    ds_read_b128 v[180:183], v8 offset:25600
    buffer_load_dwordx4 v3, s[8:11], s30 offen offset:1024 sc1 lds
    s_waitcnt lgkmcnt(4)
    v_mfma_f32_32x32x16_bf16 v[96:111], v[192:195], a[88:91], v[96:111]
    ds_read_b128 v[184:187], v8 offset:26624
    buffer_load_dwordx4 v3, s[8:11], s30 offen offset:2048 sc1 lds
    s_waitcnt vmcnt(27)
    v_mfma_f32_32x32x16_bf16 v[64:79], v[196:199], a[92:95], v[64:79]
    ds_read_b128 v[188:191], v8 offset:27648
    buffer_load_dwordx4 v3, s[8:11], s30 offen offset:3072 sc1 lds
    s_add_u32 s30, s30, 16384
    s_waitcnt lgkmcnt(4)
    v_mfma_f32_32x32x16_bf16 v[80:95], v[200:203], a[92:95], v[80:95]
    ds_read_b128 v[192:195], v8 offset:28672
    v_mfma_f32_32x32x16_bf16 v[96:111], v[204:207], a[92:95], v[96:111]
    ds_read_b128 v[196:199], v8 offset:29696
    s_waitcnt vmcnt(27)
    s_waitcnt lgkmcnt(4)
    v_mfma_f32_32x32x16_bf16 v[64:79], v[176:179], a[96:99], v[64:79]
    ds_read_b128 v[200:203], v8 offset:30720
    v_mfma_f32_32x32x16_bf16 v[80:95], v[180:183], a[96:99], v[80:95]
    ds_read_b128 v[204:207], v8 offset:31744
    s_waitcnt lgkmcnt(4)
    v_mfma_f32_32x32x16_bf16 v[96:111], v[184:187], a[96:99], v[96:111]
    ds_read_b128 v[176:179], v8 offset:32768
    s_waitcnt vmcnt(26)
    v_mfma_f32_32x32x16_bf16 v[64:79], v[188:191], a[100:103], v[64:79]
    ds_read_b128 v[180:183], v8 offset:33792
    s_waitcnt lgkmcnt(4)
    v_mfma_f32_32x32x16_bf16 v[80:95], v[192:195], a[100:103], v[80:95]
    ds_read_b128 v[184:187], v8 offset:34816
    s_add_u32 s66, s66, 4096
    s_cmp_ge_u32 s66, 28672
    s_cselect_b32 s68, 28672, 0
    s_sub_u32 s66, s66, s68
    s_add_u32 s42, s67, s66
    s_add_u32 s43, s42, s78
    buffer_load_dwordx4 a[192:195], v3, s[8:11], s42 offen offset:0 sc1
    v_mfma_f32_32x32x16_bf16 v[96:111], v[196:199], a[100:103], v[96:111]
    ds_read_b128 v[188:191], v8 offset:35840
    buffer_load_dwordx4 a[196:199], v3, s[8:11], s43 offen offset:0 sc1
    s_waitcnt vmcnt(27)
    s_waitcnt lgkmcnt(4)
    v_mfma_f32_32x32x16_bf16 v[64:79], v[200:203], a[104:107], v[64:79]
    ds_read_b128 v[192:195], v8 offset:36864
    buffer_load_dwordx4 a[200:203], v3, s[8:11], s42 offen offset:1024 sc1
    v_mfma_f32_32x32x16_bf16 v[80:95], v[204:207], a[104:107], v[80:95]
    ds_read_b128 v[196:199], v8 offset:37888
    buffer_load_dwordx4 a[204:207], v3, s[8:11], s43 offen offset:1024 sc1
    s_waitcnt lgkmcnt(4)
    v_mfma_f32_32x32x16_bf16 v[96:111], v[176:179], a[104:107], v[96:111]
    ds_read_b128 v[200:203], v8 offset:38912
    buffer_load_dwordx4 a[208:211], v3, s[8:11], s42 offen offset:2048 sc1
    s_waitcnt vmcnt(29)
    v_mfma_f32_32x32x16_bf16 v[64:79], v[180:183], a[108:111], v[64:79]
    ds_read_b128 v[204:207], v8 offset:39936
    buffer_load_dwordx4 a[212:215], v3, s[8:11], s43 offen offset:2048 sc1
    s_waitcnt lgkmcnt(4)
    v_mfma_f32_32x32x16_bf16 v[80:95], v[184:187], a[108:111], v[80:95]
    ds_read_b128 v[176:179], v8 offset:40960
    buffer_load_dwordx4 a[216:219], v3, s[8:11], s42 offen offset:3072 sc1
    v_mfma_f32_32x32x16_bf16 v[96:111], v[188:191], a[108:111], v[96:111]
    ds_read_b128 v[180:183], v8 offset:41984
    buffer_load_dwordx4 a[220:223], v3, s[8:11], s43 offen offset:3072 sc1
    s_waitcnt vmcnt(31)
    s_waitcnt lgkmcnt(4)
    v_mfma_f32_32x32x16_bf16 v[64:79], v[192:195], a[112:115], v[64:79]
    ds_read_b128 v[184:187], v8 offset:43008
    v_mfma_f32_32x32x16_bf16 v[80:95], v[196:199], a[112:115], v[80:95]
    ds_read_b128 v[188:191], v8 offset:44032
    s_waitcnt lgkmcnt(4)
    v_mfma_f32_32x32x16_bf16 v[96:111], v[200:203], a[112:115], v[96:111]
    ds_read_b128 v[192:195], v8 offset:45056
    s_waitcnt vmcnt(30)
    v_mfma_f32_32x32x16_bf16 v[64:79], v[204:207], a[116:119], v[64:79]
    ds_read_b128 v[196:199], v8 offset:46080
    s_waitcnt lgkmcnt(4)
    v_mfma_f32_32x32x16_bf16 v[80:95], v[176:179], a[116:119], v[80:95]
    ds_read_b128 v[200:203], v8 offset:47104
    v_mfma_f32_32x32x16_bf16 v[96:111], v[180:183], a[116:119], v[96:111]
    ds_read_b128 v[204:207], v8 offset:48128
    s_waitcnt vmcnt(29)
    s_waitcnt lgkmcnt(4)
    v_mfma_f32_32x32x16_bf16 v[64:79], v[184:187], a[120:123], v[64:79]
    ds_read_b128 v[176:179], v3 offset:0
    v_mfma_f32_32x32x16_bf16 v[80:95], v[188:191], a[120:123], v[80:95]
    ds_read_b128 v[180:183], v3 offset:1024
    s_waitcnt lgkmcnt(4)
    v_mfma_f32_32x32x16_bf16 v[96:111], v[192:195], a[120:123], v[96:111]
    ds_read_b128 v[184:187], v3 offset:2048
    s_waitcnt vmcnt(28)
    v_mfma_f32_32x32x16_bf16 v[64:79], v[196:199], a[124:127], v[64:79]
    ds_read_b128 v[188:191], v3 offset:3072
    s_waitcnt lgkmcnt(4)
    v_mfma_f32_32x32x16_bf16 v[80:95], v[200:203], a[124:127], v[80:95]
    ds_read_b128 v[192:195], v3 offset:4096
    v_mfma_f32_32x32x16_bf16 v[96:111], v[204:207], a[124:127], v[96:111]
    ds_read_b128 v[196:199], v3 offset:5120
    s_waitcnt lgkmcnt(4)
    v_mfma_f32_32x32x16_bf16 v[112:127], v[176:179], a[0:3], v[112:127]
    ds_read_b128 v[200:203], v3 offset:6144
    v_mfma_f32_32x32x16_bf16 v[112:127], v[180:183], a[4:7], v[112:127]
    ds_read_b128 v[204:207], v3 offset:7168
    s_waitcnt lgkmcnt(4)
    v_mfma_f32_32x32x16_bf16 v[112:127], v[184:187], a[8:11], v[112:127]
    ds_read_b128 v[176:179], v3 offset:8192
    v_mul_f32 v16, v64, v62
    v_mul_f32 v17, v65, v62
    v_mul_f32 v18, v66, v62
    v_mul_f32 v19, v67, v62
    v_mfma_f32_32x32x16_bf16 v[112:127], v[188:191], a[12:15], v[112:127]
    ds_read_b128 v[180:183], v3 offset:9216
    v_mul_f32 v20, v68, v62
    v_mul_f32 v21, v69, v62
    v_mul_f32 v22, v70, v62
    v_mul_f32 v23, v71, v62
    s_waitcnt lgkmcnt(4)
    v_mfma_f32_32x32x16_bf16 v[112:127], v[192:195], a[16:19], v[112:127]
    ds_read_b128 v[184:187], v3 offset:10240
    s_add_u32 m0, s31, 114688
    s_nop 0
    buffer_load_dwordx4 v3, s[8:11], s30 offen offset:0 sc1 lds
    v_exp_f32 v16, v16
    v_mfma_f32_32x32x16_bf16 v[112:127], v[196:199], a[20:23], v[112:127]
    ds_read_b128 v[188:191], v3 offset:11264
    buffer_load_dwordx4 v3, s[8:11], s30 offen offset:1024 sc1 lds
    v_exp_f32 v17, v17
    s_waitcnt lgkmcnt(4)
    v_mfma_f32_32x32x16_bf16 v[112:127], v[200:203], a[24:27], v[112:127]
    ds_read_b128 v[192:195], v3 offset:12288
    buffer_load_dwordx4 v3, s[8:11], s30 offen offset:2048 sc1 lds
    v_exp_f32 v18, v18
    v_mfma_f32_32x32x16_bf16 v[112:127], v[204:207], a[28:31], v[112:127]
    ds_read_b128 v[196:199], v3 offset:13312
    buffer_load_dwordx4 v3, s[8:11], s30 offen offset:3072 sc1 lds
    s_add_u32 s30, s30, 16384
    v_exp_f32 v19, v19
    v_exp_f32 v20, v20
    s_waitcnt lgkmcnt(4)
    v_mfma_f32_32x32x16_bf16 v[112:127], v[176:179], a[32:35], v[112:127]
    ds_read_b128 v[200:203], v3 offset:14336
    v_exp_f32 v21, v21
    v_mfma_f32_32x32x16_bf16 v[112:127], v[180:183], a[36:39], v[112:127]
    ds_read_b128 v[204:207], v3 offset:15360
    v_exp_f32 v22, v22
    v_exp_f32 v23, v23
    v_fma_f32 v16, v16, v61, v61
    v_fma_f32 v17, v17, v61, v61
    s_waitcnt lgkmcnt(4)
    v_mfma_f32_32x32x16_bf16 v[112:127], v[184:187], a[40:43], v[112:127]
    ds_read_b128 v[176:179], v3 offset:16384
    v_fma_f32 v18, v18, v61, v61
    v_fma_f32 v19, v19, v61, v61
    v_fma_f32 v20, v20, v61, v61
    v_fma_f32 v21, v21, v61, v61
    v_mfma_f32_32x32x16_bf16 v[112:127], v[188:191], a[44:47], v[112:127]
    ds_read_b128 v[180:183], v3 offset:17408
    v_fma_f32 v22, v22, v61, v61
    v_fma_f32 v23, v23, v61, v61
    v_rcp_f32 v16, v16
    s_waitcnt lgkmcnt(4)
    v_mfma_f32_32x32x16_bf16 v[112:127], v[192:195], a[48:51], v[112:127]
    ds_read_b128 v[184:187], v3 offset:18432
    s_add_u32 s66, s66, 4096
    s_cmp_ge_u32 s66, 28672
    s_cselect_b32 s68, 28672, 0
    s_sub_u32 s66, s66, s68
    s_add_u32 s42, s67, s66
    s_add_u32 s43, s42, s78
    buffer_load_dwordx4 a[224:227], v3, s[8:11], s42 offen offset:0 sc1
    v_mfma_f32_32x32x16_bf16 v[112:127], v[196:199], a[52:55], v[112:127]
    ds_read_b128 v[188:191], v3 offset:19456
    buffer_load_dwordx4 a[228:231], v3, s[8:11], s43 offen offset:0 sc1
    s_waitcnt lgkmcnt(4)
    v_mfma_f32_32x32x16_bf16 v[112:127], v[200:203], a[56:59], v[112:127]
    ds_read_b128 v[192:195], v3 offset:20480
    buffer_load_dwordx4 a[232:235], v3, s[8:11], s42 offen offset:1024 sc1
    v_rcp_f32 v17, v17
    v_mfma_f32_32x32x16_bf16 v[112:127], v[204:207], a[60:63], v[112:127]
    ds_read_b128 v[196:199], v3 offset:21504
    buffer_load_dwordx4 a[236:239], v3, s[8:11], s43 offen offset:1024 sc1
    v_rcp_f32 v18, v18
    v_rcp_f32 v19, v19
    s_waitcnt lgkmcnt(4)
    v_mfma_f32_32x32x16_bf16 v[112:127], v[176:179], a[64:67], v[112:127]
    ds_read_b128 v[200:203], v3 offset:22528
    v_rcp_f32 v20, v20
    v_mfma_f32_32x32x16_bf16 v[112:127], v[180:183], a[68:71], v[112:127]
    ds_read_b128 v[204:207], v3 offset:23552
    v_rcp_f32 v21, v21
    v_rcp_f32 v22, v22
    v_rcp_f32 v23, v23
    s_waitcnt lgkmcnt(4)
    v_mfma_f32_32x32x16_bf16 v[112:127], v[184:187], a[72:75], v[112:127]
    ds_read_b128 v[176:179], v3 offset:24576
    v_mul_f32 v16, v16, v72
    v_mul_f32 v17, v17, v73
    v_mul_f32 v18, v18, v74
    v_mul_f32 v19, v19, v75
    v_mfma_f32_32x32x16_bf16 v[112:127], v[188:191], a[76:79], v[112:127]
    ds_read_b128 v[180:183], v3 offset:25600
    v_mul_f32 v20, v20, v76
    v_mul_f32 v21, v21, v77
    v_mul_f32 v22, v22, v78
    v_mul_f32 v23, v23, v79
    v_cvt_pk_bf16_f32 v64, v16, v17
    s_waitcnt lgkmcnt(4)
    v_mfma_f32_32x32x16_bf16 v[112:127], v[192:195], a[80:83], v[112:127]
    ds_read_b128 v[184:187], v3 offset:26624
    s_add_u32 m0, s31, 131072
    s_nop 0
    buffer_load_dwordx4 v3, s[8:11], s30 offen offset:0 sc1 lds
    v_cvt_pk_bf16_f32 v65, v18, v19
    v_mfma_f32_32x32x16_bf16 v[112:127], v[196:199], a[84:87], v[112:127]
    ds_read_b128 v[188:191], v3 offset:27648
    buffer_load_dwordx4 v3, s[8:11], s30 offen offset:1024 sc1 lds
    v_cvt_pk_bf16_f32 v66, v20, v21
    v_cvt_pk_bf16_f32 v67, v22, v23
    s_waitcnt lgkmcnt(4)
    v_mfma_f32_32x32x16_bf16 v[112:127], v[200:203], a[88:91], v[112:127]
    ds_read_b128 v[192:195], v3 offset:28672
    buffer_load_dwordx4 v3, s[8:11], s30 offen offset:2048 sc1 lds
    v_mul_f32 v24, v80, v62
    v_mul_f32 v25, v81, v62
    v_mfma_f32_32x32x16_bf16 v[112:127], v[204:207], a[92:95], v[112:127]
    ds_read_b128 v[196:199], v3 offset:29696
    buffer_load_dwordx4 v3, s[8:11], s30 offen offset:3072 sc1 lds
    s_add_u32 s30, s30, 16384
    v_mul_f32 v26, v82, v62
    v_mul_f32 v27, v83, v62
    s_waitcnt lgkmcnt(4)
    v_mfma_f32_32x32x16_bf16 v[112:127], v[176:179], a[96:99], v[112:127]
    ds_read_b128 v[200:203], v3 offset:30720
    buffer_store_dwordx4 v[64:67], v3, s[8:11], s34 offen offset:0 sc1
    v_mul_f32 v28, v84, v62
    v_mul_f32 v29, v85, v62
    v_mfma_f32_32x32x16_bf16 v[112:127], v[180:183], a[100:103], v[112:127]
    ds_read_b128 v[204:207], v3 offset:31744
    v_mul_f32 v30, v86, v62
    v_mul_f32 v31, v87, v62
    v_exp_f32 v24, v24
    s_waitcnt lgkmcnt(4)
    v_mfma_f32_32x32x16_bf16 v[112:127], v[184:187], a[104:107], v[112:127]
    ds_read_b128 v[176:179], v3 offset:32768
    v_exp_f32 v25, v25
    v_exp_f32 v26, v26
    v_mfma_f32_32x32x16_bf16 v[112:127], v[188:191], a[108:111], v[112:127]
    ds_read_b128 v[180:183], v3 offset:33792
    v_exp_f32 v27, v27
    v_exp_f32 v28, v28
    v_exp_f32 v29, v29
    s_waitcnt lgkmcnt(4)
    v_mfma_f32_32x32x16_bf16 v[112:127], v[192:195], a[112:115], v[112:127]
    ds_read_b128 v[184:187], v3 offset:34816
    buffer_load_dwordx4 a[240:243], v3, s[8:11], s42 offen offset:2048 sc1
    v_exp_f32 v30, v30
    v_mfma_f32_32x32x16_bf16 v[112:127], v[196:199], a[116:119], v[112:127]
    ds_read_b128 v[188:191], v3 offset:35840
    buffer_load_dwordx4 a[244:247], v3, s[8:11], s43 offen offset:2048 sc1
    v_exp_f32 v31, v31
    v_fma_f32 v24, v24, v61, v61
    s_waitcnt lgkmcnt(4)
    v_mfma_f32_32x32x16_bf16 v[112:127], v[200:203], a[120:123], v[112:127]
    ds_read_b128 v[192:195], v3 offset:36864
    buffer_load_dwordx4 a[248:251], v3, s[8:11], s42 offen offset:3072 sc1
    v_fma_f32 v25, v25, v61, v61
    v_fma_f32 v26, v26, v61, v61
    v_mfma_f32_32x32x16_bf16 v[112:127], v[204:207], a[124:127], v[112:127]
    ds_read_b128 v[196:199], v3 offset:37888
    buffer_load_dwordx4 a[252:255], v3, s[8:11], s43 offen offset:3072 sc1
    v_fma_f32 v27, v27, v61, v61
    v_fma_f32 v28, v28, v61, v61
    v_fma_f32 v29, v29, v61, v61
    v_fma_f32 v30, v30, v61, v61
    s_waitcnt lgkmcnt(4)
    v_mfma_f32_32x32x16_bf16 v[128:143], v[176:179], a[0:3], v[128:143]
    ds_read_b128 v[200:203], v3 offset:38912
    v_fma_f32 v31, v31, v61, v61
    v_rcp_f32 v24, v24
    v_mfma_f32_32x32x16_bf16 v[128:143], v[180:183], a[4:7], v[128:143]
    ds_read_b128 v[204:207], v3 offset:39936
    v_rcp_f32 v25, v25
    v_rcp_f32 v26, v26
    s_waitcnt lgkmcnt(4)
    v_mfma_f32_32x32x16_bf16 v[128:143], v[184:187], a[8:11], v[128:143]
    ds_read_b128 v[176:179], v3 offset:40960
    v_rcp_f32 v27, v27
    v_rcp_f32 v28, v28
    v_mfma_f32_32x32x16_bf16 v[128:143], v[188:191], a[12:15], v[128:143]
    ds_read_b128 v[180:183], v3 offset:41984
    v_rcp_f32 v29, v29
    v_rcp_f32 v30, v30
    v_rcp_f32 v31, v31
    s_waitcnt lgkmcnt(4)
    v_mfma_f32_32x32x16_bf16 v[128:143], v[192:195], a[16:19], v[128:143]
    ds_read_b128 v[184:187], v3 offset:43008
    s_add_u32 m0, s31, 147456
    s_nop 0
    buffer_load_dwordx4 v3, s[8:11], s30 offen offset:0 sc1 lds
    v_mul_f32 v24, v24, v88
    v_mfma_f32_32x32x16_bf16 v[128:143], v[196:199], a[20:23], v[128:143]
    ds_read_b128 v[188:191], v3 offset:44032
    buffer_load_dwordx4 v3, s[8:11], s30 offen offset:1024 sc1 lds
    v_mul_f32 v25, v25, v89
    v_mul_f32 v26, v26, v90
    v_mul_f32 v27, v27, v91
    s_waitcnt lgkmcnt(4)
    v_mfma_f32_32x32x16_bf16 v[128:143], v[200:203], a[24:27], v[128:143]
    ds_read_b128 v[192:195], v3 offset:45056
    buffer_load_dwordx4 v3, s[8:11], s30 offen offset:2048 sc1 lds
    v_mul_f32 v28, v28, v92
    v_mul_f32 v29, v29, v93
    v_mfma_f32_32x32x16_bf16 v[128:143], v[204:207], a[28:31], v[128:143]
    ds_read_b128 v[196:199], v3 offset:46080
    buffer_load_dwordx4 v3, s[8:11], s30 offen offset:3072 sc1 lds
    s_add_u32 s30, s30, 16384
    v_mul_f32 v30, v30, v94
    v_mul_f32 v31, v31, v95
    v_cvt_pk_bf16_f32 v80, v24, v25
    s_waitcnt lgkmcnt(4)
    v_mfma_f32_32x32x16_bf16 v[128:143], v[176:179], a[32:35], v[128:143]
    ds_read_b128 v[200:203], v3 offset:47104
    v_cvt_pk_bf16_f32 v81, v26, v27
    v_cvt_pk_bf16_f32 v82, v28, v29
    v_cvt_pk_bf16_f32 v83, v30, v31
    v_mfma_f32_32x32x16_bf16 v[128:143], v[180:183], a[36:39], v[128:143]
    ds_read_b128 v[204:207], v3 offset:48128
    buffer_store_dwordx4 v[80:83], v3, s[8:11], s34 offen offset:1024 sc1
    v_mul_f32 v16, v96, v62
    v_mul_f32 v17, v97, v62
    s_waitcnt lgkmcnt(4)
    v_mfma_f32_32x32x16_bf16 v[128:143], v[184:187], a[40:43], v[128:143]
    ds_read_b128 v[176:179], v8 offset:0
    v_mul_f32 v18, v98, v62
    v_mul_f32 v19, v99, v62
    v_mul_f32 v20, v100, v62
    v_mul_f32 v21, v101, v62
    v_mfma_f32_32x32x16_bf16 v[128:143], v[188:191], a[44:47], v[128:143]
    ds_read_b128 v[180:183], v8 offset:1024
    v_mul_f32 v22, v102, v62
    v_mul_f32 v23, v103, v62
    v_exp_f32 v16, v16
    s_waitcnt lgkmcnt(4)
    v_mfma_f32_32x32x16_bf16 v[128:143], v[192:195], a[48:51], v[128:143]
    ds_read_b128 v[184:187], v8 offset:2048
    s_add_u32 s66, s66, 4096
    s_cmp_ge_u32 s66, 28672
    s_cselect_b32 s68, 28672, 0
    s_sub_u32 s66, s66, s68
    s_add_u32 s42, s67, s66
    s_add_u32 s43, s42, s78
    buffer_load_dwordx4 v[208:211], v3, s[8:11], s42 offen offset:0 sc1
    v_mfma_f32_32x32x16_bf16 v[128:143], v[196:199], a[52:55], v[128:143]
    ds_read_b128 v[188:191], v8 offset:3072
    buffer_load_dwordx4 v[212:215], v3, s[8:11], s43 offen offset:0 sc1
    s_waitcnt lgkmcnt(4)
    v_mfma_f32_32x32x16_bf16 v[128:143], v[200:203], a[56:59], v[128:143]
    ds_read_b128 v[192:195], v8 offset:4096
    buffer_load_dwordx4 v[216:219], v3, s[8:11], s42 offen offset:1024 sc1
    v_exp_f32 v17, v17
    v_mfma_f32_32x32x16_bf16 v[128:143], v[204:207], a[60:63], v[128:143]
    ds_read_b128 v[196:199], v8 offset:5120
    buffer_load_dwordx4 v[220:223], v3, s[8:11], s43 offen offset:1024 sc1
    v_exp_f32 v18, v18
    v_exp_f32 v19, v19
    s_waitcnt lgkmcnt(4)
    v_mfma_f32_32x32x16_bf16 v[128:143], v[176:179], a[64:67], v[128:143]
    ds_read_b128 v[200:203], v8 offset:6144
    buffer_load_dwordx4 v[224:227], v3, s[8:11], s42 offen offset:2048 sc1
    v_exp_f32 v20, v20
    v_mfma_f32_32x32x16_bf16 v[128:143], v[180:183], a[68:71], v[128:143]
    ds_read_b128 v[204:207], v8 offset:7168
    buffer_load_dwordx4 v[228:231], v3, s[8:11], s43 offen offset:2048 sc1
    v_exp_f32 v21, v21
    s_waitcnt lgkmcnt(4)
    v_mfma_f32_32x32x16_bf16 v[128:143], v[184:187], a[72:75], v[128:143]
    ds_read_b128 v[176:179], v8 offset:8192
    buffer_load_dwordx4 v[232:235], v3, s[8:11], s42 offen offset:3072 sc1
    v_exp_f32 v22, v22
    v_mfma_f32_32x32x16_bf16 v[128:143], v[188:191], a[76:79], v[128:143]
    ds_read_b128 v[180:183], v8 offset:9216
    buffer_load_dwordx4 v[236:239], v3, s[8:11], s43 offen offset:3072 sc1
    v_exp_f32 v23, v23
    v_fma_f32 v16, v16, v61, v61
    v_fma_f32 v17, v17, v61, v61
    v_fma_f32 v18, v18, v61, v61
    s_waitcnt lgkmcnt(4)
    v_mfma_f32_32x32x16_bf16 v[128:143], v[192:195], a[80:83], v[128:143]
    ds_read_b128 v[184:187], v8 offset:10240
    s_add_u32 s66, s66, 4096
    s_cmp_ge_u32 s66, 28672
    s_cselect_b32 s68, 28672, 0
    s_sub_u32 s66, s66, s68
    s_add_u32 s42, s67, s66
    s_add_u32 s43, s42, s78
    buffer_load_dwordx4 v[240:243], v3, s[8:11], s42 offen offset:0 sc1
    v_mfma_f32_32x32x16_bf16 v[128:143], v[196:199], a[84:87], v[128:143]
    ds_read_b128 v[188:191], v8 offset:11264
    buffer_load_dwordx4 v[244:247], v3, s[8:11], s43 offen offset:0 sc1
    s_waitcnt lgkmcnt(4)
    v_mfma_f32_32x32x16_bf16 v[128:143], v[200:203], a[88:91], v[128:143]
    ds_read_b128 v[192:195], v8 offset:12288
    v_fma_f32 v19, v19, v61, v61
    v_fma_f32 v20, v20, v61, v61
    v_fma_f32 v21, v21, v61, v61
    v_mfma_f32_32x32x16_bf16 v[128:143], v[204:207], a[92:95], v[128:143]
    ds_read_b128 v[196:199], v8 offset:13312
    v_fma_f32 v22, v22, v61, v61
    v_fma_f32 v23, v23, v61, v61
    v_rcp_f32 v16, v16
    s_waitcnt lgkmcnt(4)
    v_mfma_f32_32x32x16_bf16 v[128:143], v[176:179], a[96:99], v[128:143]
    ds_read_b128 v[200:203], v8 offset:14336
    v_rcp_f32 v17, v17
    v_rcp_f32 v18, v18
    v_mfma_f32_32x32x16_bf16 v[128:143], v[180:183], a[100:103], v[128:143]
    ds_read_b128 v[204:207], v8 offset:15360
    v_rcp_f32 v19, v19
    v_rcp_f32 v20, v20
    s_waitcnt lgkmcnt(4)
    v_mfma_f32_32x32x16_bf16 v[128:143], v[184:187], a[104:107], v[128:143]
    s_waitcnt vmcnt(40)
    s_barrier
    ds_read_b128 v[176:179], v9 offset:0
    v_rcp_f32 v21, v21
    v_mfma_f32_32x32x16_bf16 v[128:143], v[188:191], a[108:111], v[128:143]
    ds_read_b128 v[180:183], v9 offset:1024
    v_rcp_f32 v22, v22
    v_rcp_f32 v23, v23
    v_mul_f32 v16, v16, v104
    v_mul_f32 v17, v17, v105
    s_waitcnt lgkmcnt(4)
    v_mfma_f32_32x32x16_bf16 v[128:143], v[192:195], a[112:115], v[128:143]
    ds_read_b128 v[184:187], v9 offset:2048
    v_mul_f32 v18, v18, v106
    v_mul_f32 v19, v19, v107
    v_mul_f32 v20, v20, v108
    v_mfma_f32_32x32x16_bf16 v[128:143], v[196:199], a[116:119], v[128:143]
    ds_read_b128 v[188:191], v9 offset:3072
    v_mul_f32 v21, v21, v109
    v_mul_f32 v22, v22, v110
    v_mul_f32 v23, v23, v111
    v_cvt_pk_bf16_f32 v96, v16, v17
    v_cvt_pk_bf16_f32 v97, v18, v19
    s_waitcnt lgkmcnt(4)
    v_mfma_f32_32x32x16_bf16 v[128:143], v[200:203], a[120:123], v[128:143]
    ds_read_b128 v[192:195], v9 offset:4096
    v_cvt_pk_bf16_f32 v98, v20, v21
    v_cvt_pk_bf16_f32 v99, v22, v23
    v_mul_f32 v24, v112, v62
    v_mul_f32 v25, v113, v62
    v_mfma_f32_32x32x16_bf16 v[128:143], v[204:207], a[124:127], v[128:143]
    ds_read_b128 v[196:199], v9 offset:5120
    buffer_store_dwordx4 v[96:99], v3, s[8:11], s34 offen offset:2048 sc1
    v_mul_f32 v26, v114, v62
    v_mul_f32 v27, v115, v62
    v_mul_f32 v28, v116, v62
    s_waitcnt lgkmcnt(4)
    v_mfma_f32_32x32x16_bf16 v[144:159], v[176:179], a[0:3], v[144:159]
    ds_read_b128 v[200:203], v9 offset:6144
    v_mul_f32 v29, v117, v62
    v_mul_f32 v30, v118, v62
    v_mul_f32 v31, v119, v62
    v_mfma_f32_32x32x16_bf16 v[144:159], v[180:183], a[4:7], v[144:159]
    ds_read_b128 v[204:207], v9 offset:7168
    v_exp_f32 v24, v24
    v_exp_f32 v25, v25
    v_exp_f32 v26, v26
    s_waitcnt lgkmcnt(4)
    v_mfma_f32_32x32x16_bf16 v[144:159], v[184:187], a[8:11], v[144:159]
    ds_read_b128 v[176:179], v9 offset:8192
    v_exp_f32 v27, v27
    v_mfma_f32_32x32x16_bf16 v[144:159], v[188:191], a[12:15], v[144:159]
    ds_read_b128 v[180:183], v9 offset:9216
    v_exp_f32 v28, v28
    v_exp_f32 v29, v29
    v_exp_f32 v30, v30
    s_waitcnt lgkmcnt(4)
    v_mfma_f32_32x32x16_bf16 v[144:159], v[192:195], a[16:19], v[144:159]
    ds_read_b128 v[184:187], v9 offset:10240
    v_exp_f32 v31, v31
    v_fma_f32 v24, v24, v61, v61
    v_fma_f32 v25, v25, v61, v61
    v_mfma_f32_32x32x16_bf16 v[144:159], v[196:199], a[20:23], v[144:159]
    ds_read_b128 v[188:191], v9 offset:11264
    v_fma_f32 v26, v26, v61, v61
    v_fma_f32 v27, v27, v61, v61
    v_fma_f32 v28, v28, v61, v61
    v_fma_f32 v29, v29, v61, v61
    v_fma_f32 v30, v30, v61, v61
    s_waitcnt lgkmcnt(4)
    v_mfma_f32_32x32x16_bf16 v[144:159], v[200:203], a[24:27], v[144:159]
    ds_read_b128 v[192:195], v9 offset:12288
    v_fma_f32 v31, v31, v61, v61
    v_rcp_f32 v24, v24
    v_mfma_f32_32x32x16_bf16 v[144:159], v[204:207], a[28:31], v[144:159]
    ds_read_b128 v[196:199], v9 offset:13312
    v_rcp_f32 v25, v25
    v_rcp_f32 v26, v26
    s_waitcnt lgkmcnt(4)
    v_mfma_f32_32x32x16_bf16 v[144:159], v[176:179], a[32:35], v[144:159]
    ds_read_b128 v[200:203], v9 offset:14336
    v_rcp_f32 v27, v27
    v_rcp_f32 v28, v28
    v_mfma_f32_32x32x16_bf16 v[144:159], v[180:183], a[36:39], v[144:159]
    ds_read_b128 v[204:207], v9 offset:15360
    v_rcp_f32 v29, v29
    v_rcp_f32 v30, v30
    v_rcp_f32 v31, v31
    s_waitcnt lgkmcnt(4)
    v_mfma_f32_32x32x16_bf16 v[144:159], v[184:187], a[40:43], v[144:159]
    s_waitcnt vmcnt(29)
    s_barrier
    ds_read_b128 v[176:179], v9 offset:16384
    v_mul_f32 v24, v24, v120
    v_mfma_f32_32x32x16_bf16 v[144:159], v[188:191], a[44:47], v[144:159]
    ds_read_b128 v[180:183], v9 offset:17408
    v_mul_f32 v25, v25, v121
    v_mul_f32 v26, v26, v122
    v_mul_f32 v27, v27, v123
    v_mul_f32 v28, v28, v124
    v_mul_f32 v29, v29, v125
    s_waitcnt lgkmcnt(4)
    v_mfma_f32_32x32x16_bf16 v[144:159], v[192:195], a[48:51], v[144:159]
    ds_read_b128 v[184:187], v9 offset:18432
    v_mul_f32 v30, v30, v126
    v_mul_f32 v31, v31, v127
    v_cvt_pk_bf16_f32 v112, v24, v25
    v_cvt_pk_bf16_f32 v113, v26, v27
    v_mfma_f32_32x32x16_bf16 v[144:159], v[196:199], a[52:55], v[144:159]
    ds_read_b128 v[188:191], v9 offset:19456
    v_cvt_pk_bf16_f32 v114, v28, v29
    v_cvt_pk_bf16_f32 v115, v30, v31
    v_mul_f32 v16, v128, v62
    v_mul_f32 v17, v129, v62
    v_mul_f32 v18, v130, v62
    s_waitcnt lgkmcnt(4)
    v_mfma_f32_32x32x16_bf16 v[144:159], v[200:203], a[56:59], v[144:159]
    ds_read_b128 v[192:195], v9 offset:20480
    buffer_store_dwordx4 v[112:115], v3, s[8:11], s34 offen offset:3072 sc1
    v_mul_f32 v19, v131, v62
    v_mul_f32 v20, v132, v62
    v_mfma_f32_32x32x16_bf16 v[144:159], v[204:207], a[60:63], v[144:159]
    ds_read_b128 v[196:199], v9 offset:21504
    v_mul_f32 v21, v133, v62
    v_mul_f32 v22, v134, v62
    v_mul_f32 v23, v135, v62
    v_exp_f32 v16, v16
    s_waitcnt lgkmcnt(4)
    v_mfma_f32_32x32x16_bf16 v[144:159], v[176:179], a[64:67], v[144:159]
    ds_read_b128 v[200:203], v9 offset:22528
    v_exp_f32 v17, v17
    v_mfma_f32_32x32x16_bf16 v[144:159], v[180:183], a[68:71], v[144:159]
    ds_read_b128 v[204:207], v9 offset:23552
    v_exp_f32 v18, v18
    v_exp_f32 v19, v19
    v_exp_f32 v20, v20
    s_waitcnt lgkmcnt(4)
    v_mfma_f32_32x32x16_bf16 v[144:159], v[184:187], a[72:75], v[144:159]
    ds_read_b128 v[176:179], v9 offset:24576
    v_exp_f32 v21, v21
    v_exp_f32 v22, v22
    v_mfma_f32_32x32x16_bf16 v[144:159], v[188:191], a[76:79], v[144:159]
    ds_read_b128 v[180:183], v9 offset:25600
    v_exp_f32 v23, v23
    v_fma_f32 v16, v16, v61, v61
    v_fma_f32 v17, v17, v61, v61
    v_fma_f32 v18, v18, v61, v61
    s_waitcnt lgkmcnt(4)
    v_mfma_f32_32x32x16_bf16 v[144:159], v[192:195], a[80:83], v[144:159]
    ds_read_b128 v[184:187], v9 offset:26624
    v_fma_f32 v19, v19, v61, v61
    v_fma_f32 v20, v20, v61, v61
    v_fma_f32 v21, v21, v61, v61
    v_mfma_f32_32x32x16_bf16 v[144:159], v[196:199], a[84:87], v[144:159]
    ds_read_b128 v[188:191], v9 offset:27648
    v_fma_f32 v22, v22, v61, v61
    v_fma_f32 v23, v23, v61, v61
    v_rcp_f32 v16, v16
    s_waitcnt lgkmcnt(4)
    v_mfma_f32_32x32x16_bf16 v[144:159], v[200:203], a[88:91], v[144:159]
    ds_read_b128 v[192:195], v9 offset:28672
    v_rcp_f32 v17, v17
    v_rcp_f32 v18, v18
    v_mfma_f32_32x32x16_bf16 v[144:159], v[204:207], a[92:95], v[144:159]
    ds_read_b128 v[196:199], v9 offset:29696
    v_rcp_f32 v19, v19
    v_rcp_f32 v20, v20
    v_rcp_f32 v21, v21
    s_waitcnt lgkmcnt(4)
    v_mfma_f32_32x32x16_bf16 v[144:159], v[176:179], a[96:99], v[144:159]
    ds_read_b128 v[200:203], v9 offset:30720
    v_rcp_f32 v22, v22
    v_mfma_f32_32x32x16_bf16 v[144:159], v[180:183], a[100:103], v[144:159]
    ds_read_b128 v[204:207], v9 offset:31744
    v_rcp_f32 v23, v23
    v_mul_f32 v16, v16, v136
    v_mul_f32 v17, v17, v137
    v_mul_f32 v18, v18, v138
    v_mul_f32 v19, v19, v139
    s_waitcnt lgkmcnt(4)
    v_mfma_f32_32x32x16_bf16 v[144:159], v[184:187], a[104:107], v[144:159]
    s_waitcnt vmcnt(22)
    s_barrier
    ds_read_b128 v[176:179], v9 offset:32768
    v_mul_f32 v20, v20, v140
    v_mul_f32 v21, v21, v141
    v_mfma_f32_32x32x16_bf16 v[144:159], v[188:191], a[108:111], v[144:159]
    ds_read_b128 v[180:183], v9 offset:33792
    v_mul_f32 v22, v22, v142
    v_mul_f32 v23, v23, v143
    v_cvt_pk_bf16_f32 v128, v16, v17
    v_cvt_pk_bf16_f32 v129, v18, v19
    v_cvt_pk_bf16_f32 v130, v20, v21
    s_waitcnt lgkmcnt(4)
    v_mfma_f32_32x32x16_bf16 v[144:159], v[192:195], a[112:115], v[144:159]
    ds_read_b128 v[184:187], v9 offset:34816
    v_cvt_pk_bf16_f32 v131, v22, v23
    v_mfma_f32_32x32x16_bf16 v[144:159], v[196:199], a[116:119], v[144:159]
    ds_read_b128 v[188:191], v9 offset:35840
    buffer_store_dwordx4 v[128:131], v3, s[8:11], s35 offen offset:0 sc1
    s_waitcnt lgkmcnt(4)
    v_mfma_f32_32x32x16_bf16 v[144:159], v[200:203], a[120:123], v[144:159]
    ds_read_b128 v[192:195], v9 offset:36864
    v_mfma_f32_32x32x16_bf16 v[144:159], v[204:207], a[124:127], v[144:159]
    ds_read_b128 v[196:199], v9 offset:37888
    s_waitcnt lgkmcnt(4)
    v_mfma_f32_32x32x16_bf16 v[160:175], v[176:179], a[0:3], v[160:175]
    ds_read_b128 v[200:203], v9 offset:38912
    v_mfma_f32_32x32x16_bf16 v[160:175], v[180:183], a[4:7], v[160:175]
    ds_read_b128 v[204:207], v9 offset:39936
    s_waitcnt lgkmcnt(4)
    v_mfma_f32_32x32x16_bf16 v[160:175], v[184:187], a[8:11], v[160:175]
    ds_read_b128 v[176:179], v9 offset:40960
    s_nop 2
    v_mul_f32 v24, v144, v62
    v_mul_f32 v25, v145, v62
    v_mul_f32 v26, v146, v62
    v_mul_f32 v27, v147, v62
    v_mfma_f32_32x32x16_bf16 v[160:175], v[188:191], a[12:15], v[160:175]
    ds_read_b128 v[180:183], v9 offset:41984
    v_mul_f32 v28, v148, v62
    v_mul_f32 v29, v149, v62
    v_mul_f32 v30, v150, v62
    v_mul_f32 v31, v151, v62
    s_waitcnt lgkmcnt(4)
    v_mfma_f32_32x32x16_bf16 v[160:175], v[192:195], a[16:19], v[160:175]
    ds_read_b128 v[184:187], v9 offset:43008
    v_exp_f32 v24, v24
    v_exp_f32 v25, v25
    v_mfma_f32_32x32x16_bf16 v[160:175], v[196:199], a[20:23], v[160:175]
    ds_read_b128 v[188:191], v9 offset:44032
    v_exp_f32 v26, v26
    v_exp_f32 v27, v27
    s_waitcnt lgkmcnt(4)
    v_mfma_f32_32x32x16_bf16 v[160:175], v[200:203], a[24:27], v[160:175]
    ds_read_b128 v[192:195], v9 offset:45056
    v_exp_f32 v28, v28
    v_exp_f32 v29, v29
    v_mfma_f32_32x32x16_bf16 v[160:175], v[204:207], a[28:31], v[160:175]
    ds_read_b128 v[196:199], v9 offset:46080
    v_exp_f32 v30, v30
    v_exp_f32 v31, v31
    v_fma_f32 v24, v24, v61, v61
    v_fma_f32 v25, v25, v61, v61
    s_waitcnt lgkmcnt(4)
    v_mfma_f32_32x32x16_bf16 v[160:175], v[176:179], a[32:35], v[160:175]
    ds_read_b128 v[200:203], v9 offset:47104
    v_fma_f32 v26, v26, v61, v61
    v_fma_f32 v27, v27, v61, v61
    v_fma_f32 v28, v28, v61, v61
    v_mfma_f32_32x32x16_bf16 v[160:175], v[180:183], a[36:39], v[160:175]
    ds_read_b128 v[204:207], v9 offset:48128
    v_fma_f32 v29, v29, v61, v61
    v_fma_f32 v30, v30, v61, v61
    v_fma_f32 v31, v31, v61, v61
    v_rcp_f32 v24, v24
    s_waitcnt lgkmcnt(4)
    v_mfma_f32_32x32x16_bf16 v[160:175], v[184:187], a[40:43], v[160:175]
    s_waitcnt vmcnt(14)
    s_barrier
    ds_read_b128 v[176:179], v10 offset:0
    v_rcp_f32 v25, v25
    v_mfma_f32_32x32x16_bf16 v[160:175], v[188:191], a[44:47], v[160:175]
    ds_read_b128 v[180:183], v10 offset:1024
    v_rcp_f32 v26, v26
    v_rcp_f32 v27, v27
    s_waitcnt lgkmcnt(4)
    v_mfma_f32_32x32x16_bf16 v[160:175], v[192:195], a[48:51], v[160:175]
    ds_read_b128 v[184:187], v10 offset:2048
    v_rcp_f32 v28, v28
    v_rcp_f32 v29, v29
    v_mfma_f32_32x32x16_bf16 v[160:175], v[196:199], a[52:55], v[160:175]
    ds_read_b128 v[188:191], v10 offset:3072
    v_rcp_f32 v30, v30
    v_rcp_f32 v31, v31
    v_mul_f32 v24, v24, v152
    s_waitcnt lgkmcnt(4)
    v_mfma_f32_32x32x16_bf16 v[160:175], v[200:203], a[56:59], v[160:175]
    ds_read_b128 v[192:195], v10 offset:4096
    v_mul_f32 v25, v25, v153
    v_mul_f32 v26, v26, v154
    v_mul_f32 v27, v27, v155
    v_mul_f32 v28, v28, v156
    v_mfma_f32_32x32x16_bf16 v[160:175], v[204:207], a[60:63], v[160:175]
    ds_read_b128 v[196:199], v10 offset:5120
    v_mul_f32 v29, v29, v157
    v_mul_f32 v30, v30, v158
    v_mul_f32 v31, v31, v159
    v_cvt_pk_bf16_f32 v144, v24, v25
    v_cvt_pk_bf16_f32 v145, v26, v27
    s_waitcnt lgkmcnt(4)
    v_mfma_f32_32x32x16_bf16 v[160:175], v[176:179], a[64:67], v[160:175]
    ds_read_b128 v[200:203], v10 offset:6144
    v_cvt_pk_bf16_f32 v146, v28, v29
    v_cvt_pk_bf16_f32 v147, v30, v31
    v_mfma_f32_32x32x16_bf16 v[160:175], v[180:183], a[68:71], v[160:175]
    ds_read_b128 v[204:207], v10 offset:7168
    buffer_store_dwordx4 v[144:147], v3, s[8:11], s35 offen offset:1024 sc1
    s_waitcnt lgkmcnt(4)
    v_mfma_f32_32x32x16_bf16 v[160:175], v[184:187], a[72:75], v[160:175]
    ds_read_b128 v[176:179], v10 offset:8192
    v_mfma_f32_32x32x16_bf16 v[160:175], v[188:191], a[76:79], v[160:175]
    ds_read_b128 v[180:183], v10 offset:9216
    s_waitcnt lgkmcnt(4)
    v_mfma_f32_32x32x16_bf16 v[160:175], v[192:195], a[80:83], v[160:175]
    ds_read_b128 v[184:187], v10 offset:10240
    v_mfma_f32_32x32x16_bf16 v[160:175], v[196:199], a[84:87], v[160:175]
    ds_read_b128 v[188:191], v10 offset:11264
    s_waitcnt lgkmcnt(4)
    v_mfma_f32_32x32x16_bf16 v[160:175], v[200:203], a[88:91], v[160:175]
    ds_read_b128 v[192:195], v10 offset:12288
    v_mfma_f32_32x32x16_bf16 v[160:175], v[204:207], a[92:95], v[160:175]
    ds_read_b128 v[196:199], v10 offset:13312
    s_waitcnt lgkmcnt(4)
    v_mfma_f32_32x32x16_bf16 v[160:175], v[176:179], a[96:99], v[160:175]
    ds_read_b128 v[200:203], v10 offset:14336
    v_mfma_f32_32x32x16_bf16 v[160:175], v[180:183], a[100:103], v[160:175]
    ds_read_b128 v[204:207], v10 offset:15360
    s_waitcnt lgkmcnt(4)
    v_mfma_f32_32x32x16_bf16 v[160:175], v[184:187], a[104:107], v[160:175]
    v_mfma_f32_32x32x16_bf16 v[160:175], v[188:191], a[108:111], v[160:175]
    s_waitcnt lgkmcnt(2)
    v_mfma_f32_32x32x16_bf16 v[160:175], v[192:195], a[112:115], v[160:175]
    v_mfma_f32_32x32x16_bf16 v[160:175], v[196:199], a[116:119], v[160:175]
    s_waitcnt lgkmcnt(0)
    v_mfma_f32_32x32x16_bf16 v[160:175], v[200:203], a[120:123], v[160:175]
    v_mfma_f32_32x32x16_bf16 v[160:175], v[204:207], a[124:127], v[160:175]
    s_nop 11
    v_mul_f32 v16, v160, v62
    v_mul_f32 v17, v161, v62
    v_mul_f32 v18, v162, v62
    v_mul_f32 v19, v163, v62
    v_mul_f32 v20, v164, v62
    v_mul_f32 v21, v165, v62
    v_mul_f32 v22, v166, v62
    v_mul_f32 v23, v167, v62
    v_exp_f32 v16, v16
    v_exp_f32 v17, v17
    v_exp_f32 v18, v18
    v_exp_f32 v19, v19
    v_exp_f32 v20, v20
    v_exp_f32 v21, v21
    v_exp_f32 v22, v22
    v_exp_f32 v23, v23
    v_fma_f32 v16, v16, v61, v61
    v_fma_f32 v17, v17, v61, v61
    v_fma_f32 v18, v18, v61, v61
    v_fma_f32 v19, v19, v61, v61
    v_fma_f32 v20, v20, v61, v61
    v_fma_f32 v21, v21, v61, v61
    v_fma_f32 v22, v22, v61, v61
    v_fma_f32 v23, v23, v61, v61
    v_rcp_f32 v16, v16
    v_rcp_f32 v17, v17
    v_rcp_f32 v18, v18
    v_rcp_f32 v19, v19
    v_rcp_f32 v20, v20
    v_rcp_f32 v21, v21
    v_rcp_f32 v22, v22
    v_rcp_f32 v23, v23
    v_mul_f32 v16, v16, v168
    v_mul_f32 v17, v17, v169
    v_mul_f32 v18, v18, v170
    v_mul_f32 v19, v19, v171
    v_mul_f32 v20, v20, v172
    v_mul_f32 v21, v21, v173
    v_mul_f32 v22, v22, v174
    v_mul_f32 v23, v23, v175
    v_cvt_pk_bf16_f32 v160, v16, v17
    v_cvt_pk_bf16_f32 v161, v18, v19
    v_cvt_pk_bf16_f32 v162, v20, v21
    v_cvt_pk_bf16_f32 v163, v22, v23
    buffer_store_dwordx4 v[160:163], v3, s[8:11], s35 offen offset:2048 sc1
    s_add_u32 s65, s64, 131072
    s_waitcnt vmcnt(0)
    s_lshl_b32 s62, s2, 7
    s_lshl_b32 s63, s20, 2
    s_add_u32 s62, s62, s63
    s_add_u32 s62, s62, s65
    v_mov_b32 v16, s6
    v_mov_b32 v17, 0
    s_mov_b64 exec, 1
    buffer_store_dword v16, v17, s[8:11], s62 offen sc1
    s_mov_b64 exec, -1
    buffer_load_dwordx4 v[128:131], v3, s[8:11], s42 offen offset:1024 sc1
    buffer_load_dwordx4 v[132:135], v3, s[8:11], s43 offen offset:1024 sc1
    buffer_load_dwordx4 v[136:139], v3, s[8:11], s42 offen offset:2048 sc1
    buffer_load_dwordx4 v[140:143], v3, s[8:11], s43 offen offset:2048 sc1
    buffer_load_dwordx4 v[144:147], v3, s[8:11], s42 offen offset:3072 sc1
    buffer_load_dwordx4 v[148:151], v3, s[8:11], s43 offen offset:3072 sc1
    s_add_u32 s66, s66, 4096
    s_cmp_ge_u32 s66, 28672
    s_cselect_b32 s68, 28672, 0
    s_sub_u32 s66, s66, s68
    s_add_u32 s42, s67, s66
    s_add_u32 s43, s42, s78
    buffer_load_dwordx4 v[152:155], v3, s[8:11], s42 offen offset:0 sc1
    buffer_load_dwordx4 v[156:159], v3, s[8:11], s43 offen offset:0 sc1
    buffer_load_dwordx4 v[160:163], v3, s[8:11], s42 offen offset:1024 sc1
    buffer_load_dwordx4 v[164:167], v3, s[8:11], s43 offen offset:1024 sc1
    buffer_load_dwordx4 v[168:171], v3, s[8:11], s42 offen offset:2048 sc1
    buffer_load_dwordx4 v[172:175], v3, s[8:11], s43 offen offset:2048 sc1
    buffer_load_dwordx4 v[176:179], v3, s[8:11], s42 offen offset:3072 sc1
    buffer_load_dwordx4 v[180:183], v3, s[8:11], s43 offen offset:3072 sc1
    s_lshr_b32 s33, s20, 1
    s_lshl_b32 s34, s23, 1
    s_add_u32 s33, s33, s34
    s_and_b32 s34, s20, 1
    s_lshl_b32 s35, s24, 1
    s_add_u32 s34, s34, s35
    s_lshl_b32 s35, s33, 5
    s_lshl_b32 s36, s34, 1
    s_add_u32 s35, s35, s36
    s_lshl_b32 s35, s35, 10
    s_add_u32 s36, s35, 2097152
    s_add_u32 s36, s36, s7
    buffer_load_dwordx4 v[8:11], v3, s[8:11], s36 offen sc1
    buffer_load_dwordx4 v[12:15], v3, s[8:11], s36 offen offset:1024 sc1
    s_mul_i32 s70, s23, 229376
    s_mul_i32 s29, s20, 28672
    s_add_u32 s70, s70, s29
    s_add_u32 s70, s70, 13631488
    s_add_u32 s70, s70, s7
    s_mov_b32 s69, 0
    s_lshr_b32 s29, s20, 1
    s_mul_i32 s29, s29, 114688
    s_add_u32 s70, s70, s29
    s_add_u32 s28, s70, s69
    s_add_u32 s29, s28, s79
    s_add_u32 s65, s64, 131072
    s_cmp_eq_u32 s20, 0
    s_cbranch_scc0 mg_WD18
    s_mov_b32 s62, 20000
mg_W17:
    buffer_load_dword v16, v253, s[8:11], s65 offen sc1
    s_waitcnt vmcnt(0)
    v_cmp_ne_u32 vcc, s6, v16
    s_nop 3
    s_cbranch_vccz mg_WD18
    s_sub_u32 s62, s62, 1
    s_cmp_lg_u32 s62, 0
    s_cbranch_scc1 mg_W17
mg_WD18:
    s_waitcnt vmcnt(0)
    s_barrier
    buffer_load_dwordx4 a[0:3], v3, s[8:11], s28 offen offset:0 sc1
    buffer_load_dwordx4 a[4:7], v3, s[8:11], s29 offen offset:0 sc1
    buffer_load_dwordx4 a[8:11], v3, s[8:11], s28 offen offset:1024 sc1
    buffer_load_dwordx4 a[12:15], v3, s[8:11], s29 offen offset:1024 sc1
    buffer_load_dwordx4 a[16:19], v3, s[8:11], s28 offen offset:2048 sc1
    buffer_load_dwordx4 a[20:23], v3, s[8:11], s29 offen offset:2048 sc1
    buffer_load_dwordx4 a[24:27], v3, s[8:11], s28 offen offset:3072 sc1
    buffer_load_dwordx4 a[28:31], v3, s[8:11], s29 offen offset:3072 sc1
    s_add_u32 s69, s69, 4096
    s_cmp_ge_u32 s69, 28672
    s_cselect_b32 s68, 28672, 0
    s_sub_u32 s69, s69, s68
    s_add_u32 s28, s70, s69
    s_add_u32 s29, s28, s79
    s_waitcnt vmcnt(7)
    v_mfma_f32_32x32x16_bf16 v[64:79], a[128:131], a[0:3], 0
    v_mfma_f32_32x32x16_bf16 v[80:95], a[132:135], a[0:3], 0
    buffer_load_dwordx4 a[32:35], v3, s[8:11], s28 offen offset:0 sc1
    buffer_load_dwordx4 a[36:39], v3, s[8:11], s29 offen offset:0 sc1
    s_waitcnt vmcnt(8)
    v_mfma_f32_32x32x16_bf16 v[96:111], a[128:131], a[4:7], 0
    v_mfma_f32_32x32x16_bf16 v[112:127], a[132:135], a[4:7], 0
    buffer_load_dwordx4 a[40:43], v3, s[8:11], s28 offen offset:1024 sc1
    buffer_load_dwordx4 a[44:47], v3, s[8:11], s29 offen offset:1024 sc1
    s_waitcnt vmcnt(9)
    v_mfma_f32_32x32x16_bf16 v[64:79], a[136:139], a[8:11], v[64:79]
    v_mfma_f32_32x32x16_bf16 v[80:95], a[140:143], a[8:11], v[80:95]
    buffer_load_dwordx4 a[48:51], v3, s[8:11], s28 offen offset:2048 sc1
    buffer_load_dwordx4 a[52:55], v3, s[8:11], s29 offen offset:2048 sc1
    s_waitcnt vmcnt(10)
    v_mfma_f32_32x32x16_bf16 v[96:111], a[136:139], a[12:15], v[96:111]
    v_mfma_f32_32x32x16_bf16 v[112:127], a[140:143], a[12:15], v[112:127]
    buffer_load_dwordx4 a[56:59], v3, s[8:11], s28 offen offset:3072 sc1
    buffer_load_dwordx4 a[60:63], v3, s[8:11], s29 offen offset:3072 sc1
    s_add_u32 s69, s69, 4096
    s_cmp_ge_u32 s69, 28672
    s_cselect_b32 s68, 28672, 0
    s_sub_u32 s69, s69, s68
    s_add_u32 s28, s70, s69
    s_add_u32 s29, s28, s79
    s_waitcnt vmcnt(11)
    v_mfma_f32_32x32x16_bf16 v[64:79], a[144:147], a[16:19], v[64:79]
    v_mfma_f32_32x32x16_bf16 v[80:95], a[148:151], a[16:19], v[80:95]
    buffer_load_dwordx4 a[64:67], v3, s[8:11], s28 offen offset:0 sc1
    buffer_load_dwordx4 a[68:71], v3, s[8:11], s29 offen offset:0 sc1
    s_waitcnt vmcnt(12)
    v_mfma_f32_32x32x16_bf16 v[96:111], a[144:147], a[20:23], v[96:111]
    v_mfma_f32_32x32x16_bf16 v[112:127], a[148:151], a[20:23], v[112:127]
    buffer_load_dwordx4 a[72:75], v3, s[8:11], s28 offen offset:1024 sc1
    buffer_load_dwordx4 a[76:79], v3, s[8:11], s29 offen offset:1024 sc1
    s_waitcnt vmcnt(13)
    v_mfma_f32_32x32x16_bf16 v[64:79], a[152:155], a[24:27], v[64:79]
    v_mfma_f32_32x32x16_bf16 v[80:95], a[156:159], a[24:27], v[80:95]
    buffer_load_dwordx4 a[80:83], v3, s[8:11], s28 offen offset:2048 sc1
    buffer_load_dwordx4 a[84:87], v3, s[8:11], s29 offen offset:2048 sc1
    s_waitcnt vmcnt(14)
    v_mfma_f32_32x32x16_bf16 v[96:111], a[152:155], a[28:31], v[96:111]
    v_mfma_f32_32x32x16_bf16 v[112:127], a[156:159], a[28:31], v[112:127]
    buffer_load_dwordx4 a[88:91], v3, s[8:11], s28 offen offset:3072 sc1
    buffer_load_dwordx4 a[92:95], v3, s[8:11], s29 offen offset:3072 sc1
    s_add_u32 s69, s69, 4096
    s_cmp_ge_u32 s69, 28672
    s_cselect_b32 s68, 28672, 0
    s_sub_u32 s69, s69, s68
    s_add_u32 s28, s70, s69
    s_add_u32 s29, s28, s79
    s_waitcnt vmcnt(15)
    v_mfma_f32_32x32x16_bf16 v[64:79], a[160:163], a[32:35], v[64:79]
    v_mfma_f32_32x32x16_bf16 v[80:95], a[164:167], a[32:35], v[80:95]
    buffer_load_dwordx4 a[96:99], v3, s[8:11], s28 offen offset:0 sc1
    buffer_load_dwordx4 a[100:103], v3, s[8:11], s29 offen offset:0 sc1
    s_waitcnt vmcnt(16)
    v_mfma_f32_32x32x16_bf16 v[96:111], a[160:163], a[36:39], v[96:111]
    v_mfma_f32_32x32x16_bf16 v[112:127], a[164:167], a[36:39], v[112:127]
    s_waitcnt vmcnt(15)
    v_mfma_f32_32x32x16_bf16 v[64:79], a[168:171], a[40:43], v[64:79]
    v_mfma_f32_32x32x16_bf16 v[80:95], a[172:175], a[40:43], v[80:95]
    buffer_load_dwordx4 a[104:107], v3, s[8:11], s28 offen offset:1024 sc1
    buffer_load_dwordx4 a[108:111], v3, s[8:11], s29 offen offset:1024 sc1
    s_waitcnt vmcnt(16)
    v_mfma_f32_32x32x16_bf16 v[96:111], a[168:171], a[44:47], v[96:111]
    v_mfma_f32_32x32x16_bf16 v[112:127], a[172:175], a[44:47], v[112:127]
    s_waitcnt vmcnt(15)
    v_mfma_f32_32x32x16_bf16 v[64:79], a[176:179], a[48:51], v[64:79]
    v_mfma_f32_32x32x16_bf16 v[80:95], a[180:183], a[48:51], v[80:95]
    buffer_load_dwordx4 a[112:115], v3, s[8:11], s28 offen offset:2048 sc1
    buffer_load_dwordx4 a[116:119], v3, s[8:11], s29 offen offset:2048 sc1
    s_waitcnt vmcnt(16)
    v_mfma_f32_32x32x16_bf16 v[96:111], a[176:179], a[52:55], v[96:111]
    v_mfma_f32_32x32x16_bf16 v[112:127], a[180:183], a[52:55], v[112:127]
    s_waitcnt vmcnt(15)
    v_mfma_f32_32x32x16_bf16 v[64:79], a[184:187], a[56:59], v[64:79]
    v_mfma_f32_32x32x16_bf16 v[80:95], a[188:191], a[56:59], v[80:95]
    buffer_load_dwordx4 a[120:123], v3, s[8:11], s28 offen offset:3072 sc1
    buffer_load_dwordx4 a[124:127], v3, s[8:11], s29 offen offset:3072 sc1
    s_add_u32 s69, s69, 4096
    s_cmp_ge_u32 s69, 28672
    s_cselect_b32 s68, 28672, 0
    s_sub_u32 s69, s69, s68
    s_add_u32 s28, s70, s69
    s_add_u32 s29, s28, s79
    s_waitcnt vmcnt(16)
    v_mfma_f32_32x32x16_bf16 v[96:111], a[184:187], a[60:63], v[96:111]
    v_mfma_f32_32x32x16_bf16 v[112:127], a[188:191], a[60:63], v[112:127]
    s_waitcnt vmcnt(15)
    v_mfma_f32_32x32x16_bf16 v[64:79], a[192:195], a[64:67], v[64:79]
    v_mfma_f32_32x32x16_bf16 v[80:95], a[196:199], a[64:67], v[80:95]
    buffer_load_dwordx4 a[0:3], v3, s[8:11], s28 offen offset:0 sc1
    buffer_load_dwordx4 a[4:7], v3, s[8:11], s29 offen offset:0 sc1
    s_waitcnt vmcnt(16)
    v_mfma_f32_32x32x16_bf16 v[96:111], a[192:195], a[68:71], v[96:111]
    v_mfma_f32_32x32x16_bf16 v[112:127], a[196:199], a[68:71], v[112:127]
    s_waitcnt vmcnt(15)
    v_mfma_f32_32x32x16_bf16 v[64:79], a[200:203], a[72:75], v[64:79]
    v_mfma_f32_32x32x16_bf16 v[80:95], a[204:207], a[72:75], v[80:95]
    buffer_load_dwordx4 a[8:11], v3, s[8:11], s28 offen offset:1024 sc1
    buffer_load_dwordx4 a[12:15], v3, s[8:11], s29 offen offset:1024 sc1
    s_waitcnt vmcnt(16)
    v_mfma_f32_32x32x16_bf16 v[96:111], a[200:203], a[76:79], v[96:111]
    v_mfma_f32_32x32x16_bf16 v[112:127], a[204:207], a[76:79], v[112:127]
    s_waitcnt vmcnt(15)
    v_mfma_f32_32x32x16_bf16 v[64:79], a[208:211], a[80:83], v[64:79]
    v_mfma_f32_32x32x16_bf16 v[80:95], a[212:215], a[80:83], v[80:95]
    buffer_load_dwordx4 a[16:19], v3, s[8:11], s28 offen offset:2048 sc1
    buffer_load_dwordx4 a[20:23], v3, s[8:11], s29 offen offset:2048 sc1
    s_waitcnt vmcnt(16)
    v_mfma_f32_32x32x16_bf16 v[96:111], a[208:211], a[84:87], v[96:111]
    v_mfma_f32_32x32x16_bf16 v[112:127], a[212:215], a[84:87], v[112:127]
    s_waitcnt vmcnt(15)
    v_mfma_f32_32x32x16_bf16 v[64:79], a[216:219], a[88:91], v[64:79]
    v_mfma_f32_32x32x16_bf16 v[80:95], a[220:223], a[88:91], v[80:95]
    buffer_load_dwordx4 a[24:27], v3, s[8:11], s28 offen offset:3072 sc1
    buffer_load_dwordx4 a[28:31], v3, s[8:11], s29 offen offset:3072 sc1
    s_add_u32 s69, s69, 4096
    s_cmp_ge_u32 s69, 28672
    s_cselect_b32 s68, 28672, 0
    s_sub_u32 s69, s69, s68
    s_add_u32 s28, s70, s69
    s_add_u32 s29, s28, s79
    s_waitcnt vmcnt(16)
    v_mfma_f32_32x32x16_bf16 v[96:111], a[216:219], a[92:95], v[96:111]
    v_mfma_f32_32x32x16_bf16 v[112:127], a[220:223], a[92:95], v[112:127]
    s_waitcnt vmcnt(15)
    v_mfma_f32_32x32x16_bf16 v[64:79], a[224:227], a[96:99], v[64:79]
    v_mfma_f32_32x32x16_bf16 v[80:95], a[228:231], a[96:99], v[80:95]
    buffer_load_dwordx4 a[32:35], v3, s[8:11], s28 offen offset:0 sc1
    buffer_load_dwordx4 a[36:39], v3, s[8:11], s29 offen offset:0 sc1
    s_waitcnt vmcnt(16)
    v_mfma_f32_32x32x16_bf16 v[96:111], a[224:227], a[100:103], v[96:111]
    v_mfma_f32_32x32x16_bf16 v[112:127], a[228:231], a[100:103], v[112:127]
    s_waitcnt vmcnt(15)
    v_mfma_f32_32x32x16_bf16 v[64:79], a[232:235], a[104:107], v[64:79]
    v_mfma_f32_32x32x16_bf16 v[80:95], a[236:239], a[104:107], v[80:95]
    buffer_load_dwordx4 a[40:43], v3, s[8:11], s28 offen offset:1024 sc1
    buffer_load_dwordx4 a[44:47], v3, s[8:11], s29 offen offset:1024 sc1
    s_waitcnt vmcnt(16)
    v_mfma_f32_32x32x16_bf16 v[96:111], a[232:235], a[108:111], v[96:111]
    v_mfma_f32_32x32x16_bf16 v[112:127], a[236:239], a[108:111], v[112:127]
    s_waitcnt vmcnt(15)
    v_mfma_f32_32x32x16_bf16 v[64:79], a[240:243], a[112:115], v[64:79]
    v_mfma_f32_32x32x16_bf16 v[80:95], a[244:247], a[112:115], v[80:95]
    buffer_load_dwordx4 a[48:51], v3, s[8:11], s28 offen offset:2048 sc1
    buffer_load_dwordx4 a[52:55], v3, s[8:11], s29 offen offset:2048 sc1
    s_waitcnt vmcnt(16)
    v_mfma_f32_32x32x16_bf16 v[96:111], a[240:243], a[116:119], v[96:111]
    v_mfma_f32_32x32x16_bf16 v[112:127], a[244:247], a[116:119], v[112:127]
    s_waitcnt vmcnt(15)
    v_mfma_f32_32x32x16_bf16 v[64:79], a[248:251], a[120:123], v[64:79]
    v_mfma_f32_32x32x16_bf16 v[80:95], a[252:255], a[120:123], v[80:95]
    buffer_load_dwordx4 a[56:59], v3, s[8:11], s28 offen offset:3072 sc1
    buffer_load_dwordx4 a[60:63], v3, s[8:11], s29 offen offset:3072 sc1
    s_add_u32 s69, s69, 4096
    s_cmp_ge_u32 s69, 28672
    s_cselect_b32 s68, 28672, 0
    s_sub_u32 s69, s69, s68
    s_add_u32 s28, s70, s69
    s_add_u32 s29, s28, s79
    s_waitcnt vmcnt(16)
    v_mfma_f32_32x32x16_bf16 v[96:111], a[248:251], a[124:127], v[96:111]
    v_mfma_f32_32x32x16_bf16 v[112:127], a[252:255], a[124:127], v[112:127]
    s_waitcnt vmcnt(15)
    v_mfma_f32_32x32x16_bf16 v[64:79], v[208:211], a[0:3], v[64:79]
    v_mfma_f32_32x32x16_bf16 v[80:95], v[212:215], a[0:3], v[80:95]
    buffer_load_dwordx4 a[64:67], v3, s[8:11], s28 offen offset:0 sc1
    buffer_load_dwordx4 a[68:71], v3, s[8:11], s29 offen offset:0 sc1
    s_waitcnt vmcnt(16)
    v_mfma_f32_32x32x16_bf16 v[96:111], v[208:211], a[4:7], v[96:111]
    v_mfma_f32_32x32x16_bf16 v[112:127], v[212:215], a[4:7], v[112:127]
    s_waitcnt vmcnt(15)
    v_mfma_f32_32x32x16_bf16 v[64:79], v[216:219], a[8:11], v[64:79]
    v_mfma_f32_32x32x16_bf16 v[80:95], v[220:223], a[8:11], v[80:95]
    buffer_load_dwordx4 a[72:75], v3, s[8:11], s28 offen offset:1024 sc1
    buffer_load_dwordx4 a[76:79], v3, s[8:11], s29 offen offset:1024 sc1
    s_waitcnt vmcnt(16)
    v_mfma_f32_32x32x16_bf16 v[96:111], v[216:219], a[12:15], v[96:111]
    v_mfma_f32_32x32x16_bf16 v[112:127], v[220:223], a[12:15], v[112:127]
    s_waitcnt vmcnt(15)
    v_mfma_f32_32x32x16_bf16 v[64:79], v[224:227], a[16:19], v[64:79]
    v_mfma_f32_32x32x16_bf16 v[80:95], v[228:231], a[16:19], v[80:95]
    buffer_load_dwordx4 a[80:83], v3, s[8:11], s28 offen offset:2048 sc1
    buffer_load_dwordx4 a[84:87], v3, s[8:11], s29 offen offset:2048 sc1
    s_waitcnt vmcnt(16)
    v_mfma_f32_32x32x16_bf16 v[96:111], v[224:227], a[20:23], v[96:111]
    v_mfma_f32_32x32x16_bf16 v[112:127], v[228:231], a[20:23], v[112:127]
    s_waitcnt vmcnt(15)
    v_mfma_f32_32x32x16_bf16 v[64:79], v[232:235], a[24:27], v[64:79]
    v_mfma_f32_32x32x16_bf16 v[80:95], v[236:239], a[24:27], v[80:95]
    buffer_load_dwordx4 a[88:91], v3, s[8:11], s28 offen offset:3072 sc1
    buffer_load_dwordx4 a[92:95], v3, s[8:11], s29 offen offset:3072 sc1
    s_waitcnt vmcnt(16)
    v_mfma_f32_32x32x16_bf16 v[96:111], v[232:235], a[28:31], v[96:111]
    v_mfma_f32_32x32x16_bf16 v[112:127], v[236:239], a[28:31], v[112:127]
    s_waitcnt vmcnt(15)
    v_mfma_f32_32x32x16_bf16 v[64:79], v[240:243], a[32:35], v[64:79]
    v_mfma_f32_32x32x16_bf16 v[80:95], v[244:247], a[32:35], v[80:95]
    s_waitcnt vmcnt(14)
    v_mfma_f32_32x32x16_bf16 v[96:111], v[240:243], a[36:39], v[96:111]
    v_mfma_f32_32x32x16_bf16 v[112:127], v[244:247], a[36:39], v[112:127]
    s_waitcnt vmcnt(13)
    v_mfma_f32_32x32x16_bf16 v[64:79], v[128:131], a[40:43], v[64:79]
    v_mfma_f32_32x32x16_bf16 v[80:95], v[132:135], a[40:43], v[80:95]
    s_waitcnt vmcnt(12)
    v_mfma_f32_32x32x16_bf16 v[96:111], v[128:131], a[44:47], v[96:111]
    v_mfma_f32_32x32x16_bf16 v[112:127], v[132:135], a[44:47], v[112:127]
    s_waitcnt vmcnt(11)
    v_mfma_f32_32x32x16_bf16 v[64:79], v[136:139], a[48:51], v[64:79]
    v_mfma_f32_32x32x16_bf16 v[80:95], v[140:143], a[48:51], v[80:95]
    s_waitcnt vmcnt(10)
    v_mfma_f32_32x32x16_bf16 v[96:111], v[136:139], a[52:55], v[96:111]
    v_mfma_f32_32x32x16_bf16 v[112:127], v[140:143], a[52:55], v[112:127]
    s_waitcnt vmcnt(9)
    v_mfma_f32_32x32x16_bf16 v[64:79], v[144:147], a[56:59], v[64:79]
    v_mfma_f32_32x32x16_bf16 v[80:95], v[148:151], a[56:59], v[80:95]
    s_waitcnt vmcnt(8)
    v_mfma_f32_32x32x16_bf16 v[96:111], v[144:147], a[60:63], v[96:111]
    v_mfma_f32_32x32x16_bf16 v[112:127], v[148:151], a[60:63], v[112:127]
    s_waitcnt vmcnt(7)
    v_mfma_f32_32x32x16_bf16 v[64:79], v[152:155], a[64:67], v[64:79]
    v_mfma_f32_32x32x16_bf16 v[80:95], v[156:159], a[64:67], v[80:95]
    s_waitcnt vmcnt(6)
    v_mfma_f32_32x32x16_bf16 v[96:111], v[152:155], a[68:71], v[96:111]
    v_mfma_f32_32x32x16_bf16 v[112:127], v[156:159], a[68:71], v[112:127]
    s_waitcnt vmcnt(5)
    v_mfma_f32_32x32x16_bf16 v[64:79], v[160:163], a[72:75], v[64:79]
    v_mfma_f32_32x32x16_bf16 v[80:95], v[164:167], a[72:75], v[80:95]
    s_waitcnt vmcnt(4)
    v_mfma_f32_32x32x16_bf16 v[96:111], v[160:163], a[76:79], v[96:111]
    v_mfma_f32_32x32x16_bf16 v[112:127], v[164:167], a[76:79], v[112:127]
    s_waitcnt vmcnt(3)
    v_mfma_f32_32x32x16_bf16 v[64:79], v[168:171], a[80:83], v[64:79]
    v_mfma_f32_32x32x16_bf16 v[80:95], v[172:175], a[80:83], v[80:95]
    s_waitcnt vmcnt(2)
    v_mfma_f32_32x32x16_bf16 v[96:111], v[168:171], a[84:87], v[96:111]
    v_mfma_f32_32x32x16_bf16 v[112:127], v[172:175], a[84:87], v[112:127]
    s_waitcnt vmcnt(1)
    v_mfma_f32_32x32x16_bf16 v[64:79], v[176:179], a[88:91], v[64:79]
    v_mfma_f32_32x32x16_bf16 v[80:95], v[180:183], a[88:91], v[80:95]
    s_waitcnt vmcnt(0)
    v_mfma_f32_32x32x16_bf16 v[96:111], v[176:179], a[92:95], v[96:111]
    v_mfma_f32_32x32x16_bf16 v[112:127], v[180:183], a[92:95], v[112:127]
    s_cmp_eq_u32 s3, 0
    s_cbranch_scc0 mg_NOW
    s_mul_i32 s30, s22, 98304
    s_mul_i32 s31, s20, 6144
    s_add_u32 s30, s30, s31
    s_add_u32 s30, s30, 41943040
    s_add_u32 m0, s31, 65536
    s_nop 0
    buffer_load_dwordx4 v3, s[8:11], s30 offen offset:0 sc1 lds
    buffer_load_dwordx4 v3, s[8:11], s30 offen offset:1024 sc1 lds
    buffer_load_dwordx4 v3, s[8:11], s30 offen offset:2048 sc1 lds
    buffer_load_dwordx4 v3, s[8:11], s30 offen offset:3072 sc1 lds
    s_add_u32 s30, s30, 4096
    s_add_u32 m0, s31, 69632
    s_nop 0
    buffer_load_dwordx4 v3, s[8:11], s30 offen offset:0 sc1 lds
    buffer_load_dwordx4 v3, s[8:11], s30 offen offset:1024 sc1 lds
mg_NOW:
    s_xor_b32 s37, s20, 1
    s_lshl_b32 s37, s37, 14
    v_add_u32 v28, s37, v3
    s_xor_b32 s37, s20, 2
    s_lshl_b32 s37, s37, 14
    v_add_u32 v29, s37, v3
    s_xor_b32 s37, s20, 3
    s_lshl_b32 s37, s37, 14
    v_add_u32 v30, s37, v3
    ds_write_b128 v28, v[80:83] offset:4096
    ds_write_b128 v28, v[84:87] offset:5120
    ds_write_b128 v28, v[88:91] offset:6144
    ds_write_b128 v28, v[92:95] offset:7168
    ds_write_b128 v29, v[96:99] offset:8192
    ds_write_b128 v29, v[100:103] offset:9216
    ds_write_b128 v29, v[104:107] offset:10240
    ds_write_b128 v29, v[108:111] offset:11264
    ds_write_b128 v30, v[112:115] offset:12288
    ds_write_b128 v30, v[116:119] offset:13312
    ds_write_b128 v30, v[120:123] offset:14336
    ds_write_b128 v30, v[124:127] offset:15360
    s_lshl_b32 s37, s20, 14
    v_add_u32 v7, s37, v3
    v_lshlrev_b32 v32, 16, v8
    v_and_b32 v33, 0xffff0000, v8
    v_lshlrev_b32 v34, 16, v9
    v_and_b32 v35, 0xffff0000, v9
    v_lshlrev_b32 v36, 16, v10
    v_and_b32 v37, 0xffff0000, v10
    v_lshlrev_b32 v38, 16, v11
    v_and_b32 v39, 0xffff0000, v11
    v_lshlrev_b32 v40, 16, v12
    v_and_b32 v41, 0xffff0000, v12
    v_lshlrev_b32 v42, 16, v13
    v_and_b32 v43, 0xffff0000, v13
    v_lshlrev_b32 v44, 16, v14
    v_and_b32 v45, 0xffff0000, v14
    v_lshlrev_b32 v46, 16, v15
    v_and_b32 v47, 0xffff0000, v15
    v_pk_add_f32 v[64:65], v[64:65], v[32:33]
    v_pk_add_f32 v[66:67], v[66:67], v[34:35]
    v_pk_add_f32 v[68:69], v[68:69], v[36:37]
    v_pk_add_f32 v[70:71], v[70:71], v[38:39]
    v_pk_add_f32 v[72:73], v[72:73], v[40:41]
    v_pk_add_f32 v[74:75], v[74:75], v[42:43]
    v_pk_add_f32 v[76:77], v[76:77], v[44:45]
    v_pk_add_f32 v[78:79], v[78:79], v[46:47]
    s_waitcnt lgkmcnt(0)
    s_barrier
    ds_read_b128 v[144:147], v7 offset:4096
    ds_read_b128 v[148:151], v7 offset:5120
    ds_read_b128 v[152:155], v7 offset:6144
    ds_read_b128 v[156:159], v7 offset:7168
    ds_read_b128 v[160:163], v7 offset:8192
    ds_read_b128 v[164:167], v7 offset:9216
    ds_read_b128 v[168:171], v7 offset:10240
    ds_read_b128 v[172:175], v7 offset:11264
    ds_read_b128 v[176:179], v7 offset:12288
    ds_read_b128 v[180:183], v7 offset:13312
    ds_read_b128 v[184:187], v7 offset:14336
    ds_read_b128 v[188:191], v7 offset:15360
    s_waitcnt lgkmcnt(8)
    v_pk_add_f32 v[64:65], v[64:65], v[144:145]
    v_pk_add_f32 v[66:67], v[66:67], v[146:147]
    v_pk_add_f32 v[68:69], v[68:69], v[148:149]
    v_pk_add_f32 v[70:71], v[70:71], v[150:151]
    v_pk_add_f32 v[72:73], v[72:73], v[152:153]
    v_pk_add_f32 v[74:75], v[74:75], v[154:155]
    v_pk_add_f32 v[76:77], v[76:77], v[156:157]
    v_pk_add_f32 v[78:79], v[78:79], v[158:159]
    s_waitcnt lgkmcnt(0)
    v_pk_add_f32 v[160:161], v[160:161], v[176:177]
    v_pk_add_f32 v[162:163], v[162:163], v[178:179]
    v_pk_add_f32 v[164:165], v[164:165], v[180:181]
    v_pk_add_f32 v[166:167], v[166:167], v[182:183]
    v_pk_add_f32 v[168:169], v[168:169], v[184:185]
    v_pk_add_f32 v[170:171], v[170:171], v[186:187]
    v_pk_add_f32 v[172:173], v[172:173], v[188:189]
    v_pk_add_f32 v[174:175], v[174:175], v[190:191]
    v_pk_add_f32 v[64:65], v[64:65], v[160:161]
    v_pk_add_f32 v[66:67], v[66:67], v[162:163]
    v_pk_add_f32 v[68:69], v[68:69], v[164:165]
    v_pk_add_f32 v[70:71], v[70:71], v[166:167]
    v_pk_add_f32 v[72:73], v[72:73], v[168:169]
    v_pk_add_f32 v[74:75], v[74:75], v[170:171]
    v_pk_add_f32 v[76:77], v[76:77], v[172:173]
    v_pk_add_f32 v[78:79], v[78:79], v[174:175]
    v_cvt_pk_bf16_f32 v16, v64, v65
    v_cvt_pk_bf16_f32 v17, v66, v67
    v_cvt_pk_bf16_f32 v18, v68, v69
    v_cvt_pk_bf16_f32 v19, v70, v71
    v_cvt_pk_bf16_f32 v20, v72, v73
    v_cvt_pk_bf16_f32 v21, v74, v75
    v_cvt_pk_bf16_f32 v22, v76, v77
    v_cvt_pk_bf16_f32 v23, v78, v79
    s_cmp_eq_u32 s3, 0
    s_cbranch_scc0 mg_FINAL
    s_add_u32 s40, s7, 20971520
    s_add_u32 s36, s35, 0
    s_add_u32 s36, s36, s40
    buffer_store_dwordx4 v[16:19], v3, s[8:11], s36 offen sc1
    buffer_store_dwordx4 v[20:23], v3, s[8:11], s36 offen offset:1024 sc1
    s_mov_b32 s37, 0x3f803f80
    v_mov_b32 v6, 0
    v_mov_b32 v7, 0
    v_dot2c_f32_bf16 v6, s37, v16
    v_dot2c_f32_bf16 v7, v16, v16
    v_dot2c_f32_bf16 v6, s37, v17
    v_dot2c_f32_bf16 v7, v17, v17
    v_dot2c_f32_bf16 v6, s37, v18
    v_dot2c_f32_bf16 v7, v18, v18
    v_dot2c_f32_bf16 v6, s37, v19
    v_dot2c_f32_bf16 v7, v19, v19
    v_dot2c_f32_bf16 v6, s37, v20
    v_dot2c_f32_bf16 v7, v20, v20
    v_dot2c_f32_bf16 v6, s37, v21
    v_dot2c_f32_bf16 v7, v21, v21
    v_dot2c_f32_bf16 v6, s37, v22
    v_dot2c_f32_bf16 v7, v22, v22
    v_dot2c_f32_bf16 v6, s37, v23
    v_dot2c_f32_bf16 v7, v23, v23
    s_nop 2
    v_permlane32_swap_b32 v6, v7
    v_add_f32 v6, v6, v7
    s_lshr_b32 s38, s34, 1
    s_lshl_b32 s38, s38, 15
    s_lshl_b32 s39, s33, 9
    s_add_u32 s38, s38, s39
    s_and_b32 s39, s34, 1
    s_lshl_b32 s39, s39, 3
    s_add_u32 s38, s38, s39
    s_add_u32 s38, s38, 12582912
    s_add_u32 s38, s38, s40
    v_lshlrev_b32 v8, 4, v4
    v_lshl_add_u32 v8, v5, 2, v8
    buffer_store_dword v6, v8, s[8:11], s38 offen sc1
    s_add_u32 s65, s64, 163840
    s_waitcnt vmcnt(0)
    s_lshl_b32 s62, s2, 7
    s_lshl_b32 s63, s20, 2
    s_add_u32 s62, s62, s63
    s_add_u32 s62, s62, s65
    v_mov_b32 v16, s6
    v_mov_b32 v17, 0
    s_mov_b64 exec, 1
    buffer_store_dword v16, v17, s[8:11], s62 offen sc1
    s_mov_b64 exec, -1
    v_lshlrev_b32 v7, 4, v4
    s_lshl_b32 s28, s22, 9
    s_add_u32 s28, s28, 49545216
    buffer_load_dwordx4 v[32:35], v7, s[8:11], s28 offen offset:0 sc1
    s_add_u32 s28, s28, 8192
    buffer_load_dwordx4 v[36:39], v7, s[8:11], s28 offen offset:0 sc1
    s_add_u32 s28, s28, 8192
    buffer_load_dwordx4 v[40:43], v7, s[8:11], s28 offen offset:0 sc1
    s_mul_i32 s30, s22, 98304
    s_mul_i32 s31, s20, 6144
    s_add_u32 s30, s30, s31
    s_add_u32 s30, s30, 41967616
    s_add_u32 m0, s31, 90112
    s_nop 0
    buffer_load_dwordx4 v3, s[8:11], s30 offen offset:0 sc1 lds
    buffer_load_dwordx4 v3, s[8:11], s30 offen offset:1024 sc1 lds
    buffer_load_dwordx4 v3, s[8:11], s30 offen offset:2048 sc1 lds
    buffer_load_dwordx4 v3, s[8:11], s30 offen offset:3072 sc1 lds
    s_add_u32 s30, s30, 4096
    s_add_u32 m0, s31, 94208
    s_nop 0
    buffer_load_dwordx4 v3, s[8:11], s30 offen offset:0 sc1 lds
    buffer_load_dwordx4 v3, s[8:11], s30 offen offset:1024 sc1 lds
    s_mul_i32 s30, s22, 98304
    s_mul_i32 s31, s20, 6144
    s_add_u32 s30, s30, s31
    s_add_u32 s30, s30, 41992192
    s_add_u32 m0, s31, 114688
    s_nop 0
    buffer_load_dwordx4 v3, s[8:11], s30 offen offset:0 sc1 lds
    buffer_load_dwordx4 v3, s[8:11], s30 offen offset:1024 sc1 lds
    buffer_load_dwordx4 v3, s[8:11], s30 offen offset:2048 sc1 lds
    buffer_load_dwordx4 v3, s[8:11], s30 offen offset:3072 sc1 lds
    s_add_u32 s30, s30, 4096
    s_add_u32 m0, s31, 118784
    s_nop 0
    buffer_load_dwordx4 v3, s[8:11], s30 offen offset:0 sc1 lds
    buffer_load_dwordx4 v3, s[8:11], s30 offen offset:1024 sc1 lds
    s_mul_i32 s30, s22, 98304
    s_mul_i32 s31, s20, 6144
    s_add_u32 s30, s30, s31
    s_add_u32 s30, s30, 42016768
    s_add_u32 m0, s31, 139264
    s_nop 0
    buffer_load_dwordx4 v3, s[8:11], s30 offen offset:0 sc1 lds
    buffer_load_dwordx4 v3, s[8:11], s30 offen offset:1024 sc1 lds
    buffer_load_dwordx4 v3, s[8:11], s30 offen offset:2048 sc1 lds
    buffer_load_dwordx4 v3, s[8:11], s30 offen offset:3072 sc1 lds
    s_add_u32 s30, s30, 4096
    s_add_u32 m0, s31, 143360
    s_nop 0
    buffer_load_dwordx4 v3, s[8:11], s30 offen offset:0 sc1 lds
    buffer_load_dwordx4 v3, s[8:11], s30 offen offset:1024 sc1 lds
    s_waitcnt vmcnt(18)
    v_add_f32 v32, v32, v33
    v_add_f32 v34, v34, v35
    v_add_f32 v32, v32, v34
    v_cvt_pk_bf16_f32 v33, v32, v32
    v_and_b32 v33, 0xffff0000, v33
    v_sub_f32 v34, v32, v33
    v_cvt_pk_bf16_f32 v236, v33, v34
    v_mov_b32 v237, v236
    v_mov_b32 v238, 0
    v_mov_b32 v239, 0
    v_add_f32 v36, v36, v37
    v_add_f32 v38, v38, v39
    v_add_f32 v36, v36, v38
    v_cvt_pk_bf16_f32 v37, v36, v36
    v_and_b32 v37, 0xffff0000, v37
    v_sub_f32 v38, v36, v37
    v_cvt_pk_bf16_f32 v240, v37, v38
    v_mov_b32 v241, v240
    v_mov_b32 v242, 0
    v_mov_b32 v243, 0
    v_add_f32 v40, v40, v41
    v_add_f32 v42, v42, v43
    v_add_f32 v40, v40, v42
    v_cvt_pk_bf16_f32 v41, v40, v40
    v_and_b32 v41, 0xffff0000, v41
    v_sub_f32 v42, v40, v41
    v_cvt_pk_bf16_f32 v244, v41, v42
    v_mov_b32 v245, v244
    v_mov_b32 v246, 0
    v_mov_b32 v247, 0
    s_mov_b32 s3, 1
    s_add_u32 s7, s7, 20971520
    s_add_u32 s64, s64, 163840
    s_branch mg_LAYER
mg_FINAL:
    s_mov_b32 s12, s100
    s_mov_b32 s13, s101
    v_permlane32_swap_b32 v16, v18
    v_permlane32_swap_b32 v17, v19
    v_permlane32_swap_b32 v20, v22
    v_permlane32_swap_b32 v21, v23
    v_lshlrev_b32 v6, 10, v4
    v_lshl_add_u32 v6, v5, 4, v6
    s_lshl_b32 s38, s33, 15
    s_lshl_b32 s39, s34, 6
    s_add_u32 s38, s38, s39
    s_waitcnt lgkmcnt(0)
    s_mov_b32 s14, 2097152
    s_mov_b32 s15, 0x00020000
    buffer_store_dwordx4 v[16:19], v6, s[12:15], s38 offen
    buffer_store_dwordx4 v[20:23], v6, s[12:15], s38 offen offset:32
mg_END:
    s_endpgm
mg_SLOW:
    s_waitcnt vmcnt(0)
    s_barrier
    s_lshl_b32 s27, s25, 16
    s_add_u32 s27, s27, s7
    s_lshl_b32 s28, s26, 13
    s_add_u32 s28, s28, s27
    s_add_u32 s28, s28, 4194304
    s_mov_b32 s35, 8
    s_mov_b32 s36, s28
    s_lshl_b32 s34, s20, 8
    s_add_u32 s34, s34, 82944
    v_lshl_add_u32 v10, v1, 2, s34
mg_SL1:
    buffer_load_dwordx4 v[168:171], v3, s[8:11], s36 offen sc1
    s_waitcnt vmcnt(0)
    v_mov_b32 v24, 0xff800000
    v_mfma_f32_32x32x16_bf16 v[64:79], a[0:3], v[168:171], 0
    s_nop 11
    v_max3_f32 v24, v24, v64, v65
    v_max3_f32 v24, v24, v66, v67
    v_max3_f32 v24, v24, v68, v69
    v_max3_f32 v24, v24, v70, v71
    v_max3_f32 v24, v24, v72, v73
    v_max3_f32 v24, v24, v74, v75
    v_max3_f32 v24, v24, v76, v77
    v_max3_f32 v24, v24, v78, v79
    v_mfma_f32_32x32x16_bf16 v[64:79], a[4:7], v[168:171], 0
    s_nop 11
    v_max3_f32 v24, v24, v64, v65
    v_max3_f32 v24, v24, v66, v67
    v_max3_f32 v24, v24, v68, v69
    v_max3_f32 v24, v24, v70, v71
    v_max3_f32 v24, v24, v72, v73
    v_max3_f32 v24, v24, v74, v75
    v_max3_f32 v24, v24, v76, v77
    v_max3_f32 v24, v24, v78, v79
    v_mfma_f32_32x32x16_bf16 v[64:79], a[8:11], v[168:171], 0
    s_nop 11
    v_max3_f32 v24, v24, v64, v65
    v_max3_f32 v24, v24, v66, v67
    v_max3_f32 v24, v24, v68, v69
    v_max3_f32 v24, v24, v70, v71
    v_max3_f32 v24, v24, v72, v73
    v_max3_f32 v24, v24, v74, v75
    v_max3_f32 v24, v24, v76, v77
    v_max3_f32 v24, v24, v78, v79
    v_mfma_f32_32x32x16_bf16 v[64:79], a[12:15], v[168:171], 0
    s_nop 11
    v_max3_f32 v24, v24, v64, v65
    v_max3_f32 v24, v24, v66, v67
    v_max3_f32 v24, v24, v68, v69
    v_max3_f32 v24, v24, v70, v71
    v_max3_f32 v24, v24, v72, v73
    v_max3_f32 v24, v24, v74, v75
    v_max3_f32 v24, v24, v76, v77
    v_max3_f32 v24, v24, v78, v79
    v_mfma_f32_32x32x16_bf16 v[64:79], a[16:19], v[168:171], 0
    s_nop 11
    v_max3_f32 v24, v24, v64, v65
    v_max3_f32 v24, v24, v66, v67
    v_max3_f32 v24, v24, v68, v69
    v_max3_f32 v24, v24, v70, v71
    v_max3_f32 v24, v24, v72, v73
    v_max3_f32 v24, v24, v74, v75
    v_max3_f32 v24, v24, v76, v77
    v_max3_f32 v24, v24, v78, v79
    v_mfma_f32_32x32x16_bf16 v[64:79], a[20:23], v[168:171], 0
    s_nop 11
    v_max3_f32 v24, v24, v64, v65
    v_max3_f32 v24, v24, v66, v67
    v_max3_f32 v24, v24, v68, v69
    v_max3_f32 v24, v24, v70, v71
    v_max3_f32 v24, v24, v72, v73
    v_max3_f32 v24, v24, v74, v75
    v_max3_f32 v24, v24, v76, v77
    v_max3_f32 v24, v24, v78, v79
    v_mfma_f32_32x32x16_bf16 v[64:79], a[24:27], v[168:171], 0
    s_nop 11
    v_max3_f32 v24, v24, v64, v65
    v_max3_f32 v24, v24, v66, v67
    v_max3_f32 v24, v24, v68, v69
    v_max3_f32 v24, v24, v70, v71
    v_max3_f32 v24, v24, v72, v73
    v_max3_f32 v24, v24, v74, v75
    v_max3_f32 v24, v24, v76, v77
    v_max3_f32 v24, v24, v78, v79
    v_mfma_f32_32x32x16_bf16 v[64:79], a[28:31], v[168:171], 0
    s_nop 11
    v_max3_f32 v24, v24, v64, v65
    v_max3_f32 v24, v24, v66, v67
    v_max3_f32 v24, v24, v68, v69
    v_max3_f32 v24, v24, v70, v71
    v_max3_f32 v24, v24, v72, v73
    v_max3_f32 v24, v24, v74, v75
    v_max3_f32 v24, v24, v76, v77
    v_max3_f32 v24, v24, v78, v79
    v_mfma_f32_32x32x16_bf16 v[64:79], a[32:35], v[168:171], 0
    s_nop 11
    v_max3_f32 v24, v24, v64, v65
    v_max3_f32 v24, v24, v66, v67
    v_max3_f32 v24, v24, v68, v69
    v_max3_f32 v24, v24, v70, v71
    v_max3_f32 v24, v24, v72, v73
    v_max3_f32 v24, v24, v74, v75
    v_max3_f32 v24, v24, v76, v77
    v_max3_f32 v24, v24, v78, v79
    v_mfma_f32_32x32x16_bf16 v[64:79], a[36:39], v[168:171], 0
    s_nop 11
    v_max3_f32 v24, v24, v64, v65
    v_max3_f32 v24, v24, v66, v67
    v_max3_f32 v24, v24, v68, v69
    v_max3_f32 v24, v24, v70, v71
    v_max3_f32 v24, v24, v72, v73
    v_max3_f32 v24, v24, v74, v75
    v_max3_f32 v24, v24, v76, v77
    v_max3_f32 v24, v24, v78, v79
    v_mfma_f32_32x32x16_bf16 v[64:79], a[40:43], v[168:171], 0
    s_nop 11
    v_max3_f32 v24, v24, v64, v65
    v_max3_f32 v24, v24, v66, v67
    v_max3_f32 v24, v24, v68, v69
    v_max3_f32 v24, v24, v70, v71
    v_max3_f32 v24, v24, v72, v73
    v_max3_f32 v24, v24, v74, v75
    v_max3_f32 v24, v24, v76, v77
    v_max3_f32 v24, v24, v78, v79
    v_mfma_f32_32x32x16_bf16 v[64:79], a[44:47], v[168:171], 0
    s_nop 11
    v_max3_f32 v24, v24, v64, v65
    v_max3_f32 v24, v24, v66, v67
    v_max3_f32 v24, v24, v68, v69
    v_max3_f32 v24, v24, v70, v71
    v_max3_f32 v24, v24, v72, v73
    v_max3_f32 v24, v24, v74, v75
    v_max3_f32 v24, v24, v76, v77
    v_max3_f32 v24, v24, v78, v79
    v_mfma_f32_32x32x16_bf16 v[64:79], a[48:51], v[168:171], 0
    s_nop 11
    v_max3_f32 v24, v24, v64, v65
    v_max3_f32 v24, v24, v66, v67
    v_max3_f32 v24, v24, v68, v69
    v_max3_f32 v24, v24, v70, v71
    v_max3_f32 v24, v24, v72, v73
    v_max3_f32 v24, v24, v74, v75
    v_max3_f32 v24, v24, v76, v77
    v_max3_f32 v24, v24, v78, v79
    v_mfma_f32_32x32x16_bf16 v[64:79], a[52:55], v[168:171], 0
    s_nop 11
    v_max3_f32 v24, v24, v64, v65
    v_max3_f32 v24, v24, v66, v67
    v_max3_f32 v24, v24, v68, v69
    v_max3_f32 v24, v24, v70, v71
    v_max3_f32 v24, v24, v72, v73
    v_max3_f32 v24, v24, v74, v75
    v_max3_f32 v24, v24, v76, v77
    v_max3_f32 v24, v24, v78, v79
    v_mfma_f32_32x32x16_bf16 v[64:79], a[56:59], v[168:171], 0
    s_nop 11
    v_max3_f32 v24, v24, v64, v65
    v_max3_f32 v24, v24, v66, v67
    v_max3_f32 v24, v24, v68, v69
    v_max3_f32 v24, v24, v70, v71
    v_max3_f32 v24, v24, v72, v73
    v_max3_f32 v24, v24, v74, v75
    v_max3_f32 v24, v24, v76, v77
    v_max3_f32 v24, v24, v78, v79
    v_mfma_f32_32x32x16_bf16 v[64:79], a[60:63], v[168:171], 0
    s_nop 11
    v_max3_f32 v24, v24, v64, v65
    v_max3_f32 v24, v24, v66, v67
    v_max3_f32 v24, v24, v68, v69
    v_max3_f32 v24, v24, v70, v71
    v_max3_f32 v24, v24, v72, v73
    v_max3_f32 v24, v24, v74, v75
    v_max3_f32 v24, v24, v76, v77
    v_max3_f32 v24, v24, v78, v79
    v_mov_b32 v25, v24
    s_nop 1
    v_permlane32_swap_b32 v24, v25
    v_max_f32 v24, v24, v25
    ds_write_b32 v10, v24
    v_add_u32 v10, 1024, v10
    s_add_u32 s36, s36, 1024
    s_sub_u32 s35, s35, 1
    s_cmp_lg_u32 s35, 0
    s_cbranch_scc1 mg_SL1
    s_waitcnt lgkmcnt(0)
    s_barrier
    s_mov_b32 s35, 8
    s_mov_b32 s36, s28
    v_lshlrev_b32 v10, 2, v1
    v_add_u32 v10, 82944, v10
    s_mul_i32 s34, s20, 2304
    s_add_u32 s34, s34, 9216
    v_add_u32 v8, s34, v3
    v_lshl_add_u32 v9, v1, 2, s34
mg_SL2:
    buffer_load_dwordx4 v[168:171], v3, s[8:11], s36 offen sc1
    ds_read_b32 v24, v10 offset:0
    ds_read_b32 v25, v10 offset:256
    ds_read_b32 v26, v10 offset:512
    ds_read_b32 v27, v10 offset:768
    s_waitcnt vmcnt(0) lgkmcnt(0)
    v_max3_f32 v24, v24, v25, v26
    v_max_f32 v24, v24, v27
    v_sub_f32 v80, 0, v24
    v_sub_f32 v81, 0, v24
    v_sub_f32 v82, 0, v24
    v_sub_f32 v83, 0, v24
    v_sub_f32 v84, 0, v24
    v_sub_f32 v85, 0, v24
    v_sub_f32 v86, 0, v24
    v_sub_f32 v87, 0, v24
    v_sub_f32 v88, 0, v24
    v_sub_f32 v89, 0, v24
    v_sub_f32 v90, 0, v24
    v_sub_f32 v91, 0, v24
    v_sub_f32 v92, 0, v24
    v_sub_f32 v93, 0, v24
    v_sub_f32 v94, 0, v24
    v_sub_f32 v95, 0, v24
    s_nop 1
    v_mfma_f32_32x32x16_bf16 v[64:79], a[0:3], v[168:171], v[80:95]
    s_nop 11
    v_exp_f32 v64, v64
    v_exp_f32 v65, v65
    v_exp_f32 v66, v66
    v_exp_f32 v67, v67
    v_exp_f32 v68, v68
    v_exp_f32 v69, v69
    v_exp_f32 v70, v70
    v_exp_f32 v71, v71
    v_exp_f32 v72, v72
    v_exp_f32 v73, v73
    v_exp_f32 v74, v74
    v_exp_f32 v75, v75
    v_exp_f32 v76, v76
    v_exp_f32 v77, v77
    v_exp_f32 v78, v78
    v_exp_f32 v79, v79
    v_cvt_pk_bf16_f32 v160, v64, v65
    v_cvt_pk_bf16_f32 v161, v66, v67
    v_cvt_pk_bf16_f32 v162, v68, v69
    v_cvt_pk_bf16_f32 v163, v70, v71
    v_cvt_pk_bf16_f32 v164, v72, v73
    v_cvt_pk_bf16_f32 v165, v74, v75
    v_cvt_pk_bf16_f32 v166, v76, v77
    v_cvt_pk_bf16_f32 v167, v78, v79
    v_mfma_f32_32x32x16_bf16 v[128:143], a[64:67], v[160:163], 0
    s_nop 0
    v_mfma_f32_32x32x16_bf16 v[128:143], a[68:71], v[164:167], v[128:143]
    v_mfma_f32_32x32x16_bf16 v[64:79], a[4:7], v[168:171], v[80:95]
    s_nop 11
    v_exp_f32 v64, v64
    v_exp_f32 v65, v65
    v_exp_f32 v66, v66
    v_exp_f32 v67, v67
    v_exp_f32 v68, v68
    v_exp_f32 v69, v69
    v_exp_f32 v70, v70
    v_exp_f32 v71, v71
    v_exp_f32 v72, v72
    v_exp_f32 v73, v73
    v_exp_f32 v74, v74
    v_exp_f32 v75, v75
    v_exp_f32 v76, v76
    v_exp_f32 v77, v77
    v_exp_f32 v78, v78
    v_exp_f32 v79, v79
    v_cvt_pk_bf16_f32 v160, v64, v65
    v_cvt_pk_bf16_f32 v161, v66, v67
    v_cvt_pk_bf16_f32 v162, v68, v69
    v_cvt_pk_bf16_f32 v163, v70, v71
    v_cvt_pk_bf16_f32 v164, v72, v73
    v_cvt_pk_bf16_f32 v165, v74, v75
    v_cvt_pk_bf16_f32 v166, v76, v77
    v_cvt_pk_bf16_f32 v167, v78, v79
    v_mfma_f32_32x32x16_bf16 v[128:143], a[72:75], v[160:163], v[128:143]
    s_nop 0
    v_mfma_f32_32x32x16_bf16 v[128:143], a[76:79], v[164:167], v[128:143]
    v_mfma_f32_32x32x16_bf16 v[64:79], a[8:11], v[168:171], v[80:95]
    s_nop 11
    v_exp_f32 v64, v64
    v_exp_f32 v65, v65
    v_exp_f32 v66, v66
    v_exp_f32 v67, v67
    v_exp_f32 v68, v68
    v_exp_f32 v69, v69
    v_exp_f32 v70, v70
    v_exp_f32 v71, v71
    v_exp_f32 v72, v72
    v_exp_f32 v73, v73
    v_exp_f32 v74, v74
    v_exp_f32 v75, v75
    v_exp_f32 v76, v76
    v_exp_f32 v77, v77
    v_exp_f32 v78, v78
    v_exp_f32 v79, v79
    v_cvt_pk_bf16_f32 v160, v64, v65
    v_cvt_pk_bf16_f32 v161, v66, v67
    v_cvt_pk_bf16_f32 v162, v68, v69
    v_cvt_pk_bf16_f32 v163, v70, v71
    v_cvt_pk_bf16_f32 v164, v72, v73
    v_cvt_pk_bf16_f32 v165, v74, v75
    v_cvt_pk_bf16_f32 v166, v76, v77
    v_cvt_pk_bf16_f32 v167, v78, v79
    v_mfma_f32_32x32x16_bf16 v[128:143], a[80:83], v[160:163], v[128:143]
    s_nop 0
    v_mfma_f32_32x32x16_bf16 v[128:143], a[84:87], v[164:167], v[128:143]
    v_mfma_f32_32x32x16_bf16 v[64:79], a[12:15], v[168:171], v[80:95]
    s_nop 11
    v_exp_f32 v64, v64
    v_exp_f32 v65, v65
    v_exp_f32 v66, v66
    v_exp_f32 v67, v67
    v_exp_f32 v68, v68
    v_exp_f32 v69, v69
    v_exp_f32 v70, v70
    v_exp_f32 v71, v71
    v_exp_f32 v72, v72
    v_exp_f32 v73, v73
    v_exp_f32 v74, v74
    v_exp_f32 v75, v75
    v_exp_f32 v76, v76
    v_exp_f32 v77, v77
    v_exp_f32 v78, v78
    v_exp_f32 v79, v79
    v_cvt_pk_bf16_f32 v160, v64, v65
    v_cvt_pk_bf16_f32 v161, v66, v67
    v_cvt_pk_bf16_f32 v162, v68, v69
    v_cvt_pk_bf16_f32 v163, v70, v71
    v_cvt_pk_bf16_f32 v164, v72, v73
    v_cvt_pk_bf16_f32 v165, v74, v75
    v_cvt_pk_bf16_f32 v166, v76, v77
    v_cvt_pk_bf16_f32 v167, v78, v79
    v_mfma_f32_32x32x16_bf16 v[128:143], a[88:91], v[160:163], v[128:143]
    s_nop 0
    v_mfma_f32_32x32x16_bf16 v[128:143], a[92:95], v[164:167], v[128:143]
    v_mfma_f32_32x32x16_bf16 v[64:79], a[16:19], v[168:171], v[80:95]
    s_nop 11
    v_exp_f32 v64, v64
    v_exp_f32 v65, v65
    v_exp_f32 v66, v66
    v_exp_f32 v67, v67
    v_exp_f32 v68, v68
    v_exp_f32 v69, v69
    v_exp_f32 v70, v70
    v_exp_f32 v71, v71
    v_exp_f32 v72, v72
    v_exp_f32 v73, v73
    v_exp_f32 v74, v74
    v_exp_f32 v75, v75
    v_exp_f32 v76, v76
    v_exp_f32 v77, v77
    v_exp_f32 v78, v78
    v_exp_f32 v79, v79
    v_cvt_pk_bf16_f32 v160, v64, v65
    v_cvt_pk_bf16_f32 v161, v66, v67
    v_cvt_pk_bf16_f32 v162, v68, v69
    v_cvt_pk_bf16_f32 v163, v70, v71
    v_cvt_pk_bf16_f32 v164, v72, v73
    v_cvt_pk_bf16_f32 v165, v74, v75
    v_cvt_pk_bf16_f32 v166, v76, v77
    v_cvt_pk_bf16_f32 v167, v78, v79
    v_mfma_f32_32x32x16_bf16 v[128:143], a[96:99], v[160:163], v[128:143]
    s_nop 0
    v_mfma_f32_32x32x16_bf16 v[128:143], a[100:103], v[164:167], v[128:143]
    v_mfma_f32_32x32x16_bf16 v[64:79], a[20:23], v[168:171], v[80:95]
    s_nop 11
    v_exp_f32 v64, v64
    v_exp_f32 v65, v65
    v_exp_f32 v66, v66
    v_exp_f32 v67, v67
    v_exp_f32 v68, v68
    v_exp_f32 v69, v69
    v_exp_f32 v70, v70
    v_exp_f32 v71, v71
    v_exp_f32 v72, v72
    v_exp_f32 v73, v73
    v_exp_f32 v74, v74
    v_exp_f32 v75, v75
    v_exp_f32 v76, v76
    v_exp_f32 v77, v77
    v_exp_f32 v78, v78
    v_exp_f32 v79, v79
    v_cvt_pk_bf16_f32 v160, v64, v65
    v_cvt_pk_bf16_f32 v161, v66, v67
    v_cvt_pk_bf16_f32 v162, v68, v69
    v_cvt_pk_bf16_f32 v163, v70, v71
    v_cvt_pk_bf16_f32 v164, v72, v73
    v_cvt_pk_bf16_f32 v165, v74, v75
    v_cvt_pk_bf16_f32 v166, v76, v77
    v_cvt_pk_bf16_f32 v167, v78, v79
    v_mfma_f32_32x32x16_bf16 v[128:143], a[104:107], v[160:163], v[128:143]
    s_nop 0
    v_mfma_f32_32x32x16_bf16 v[128:143], a[108:111], v[164:167], v[128:143]
    v_mfma_f32_32x32x16_bf16 v[64:79], a[24:27], v[168:171], v[80:95]
    s_nop 11
    v_exp_f32 v64, v64
    v_exp_f32 v65, v65
    v_exp_f32 v66, v66
    v_exp_f32 v67, v67
    v_exp_f32 v68, v68
    v_exp_f32 v69, v69
    v_exp_f32 v70, v70
    v_exp_f32 v71, v71
    v_exp_f32 v72, v72
    v_exp_f32 v73, v73
    v_exp_f32 v74, v74
    v_exp_f32 v75, v75
    v_exp_f32 v76, v76
    v_exp_f32 v77, v77
    v_exp_f32 v78, v78
    v_exp_f32 v79, v79
    v_cvt_pk_bf16_f32 v160, v64, v65
    v_cvt_pk_bf16_f32 v161, v66, v67
    v_cvt_pk_bf16_f32 v162, v68, v69
    v_cvt_pk_bf16_f32 v163, v70, v71
    v_cvt_pk_bf16_f32 v164, v72, v73
    v_cvt_pk_bf16_f32 v165, v74, v75
    v_cvt_pk_bf16_f32 v166, v76, v77
    v_cvt_pk_bf16_f32 v167, v78, v79
    v_mfma_f32_32x32x16_bf16 v[128:143], a[112:115], v[160:163], v[128:143]
    s_nop 0
    v_mfma_f32_32x32x16_bf16 v[128:143], a[116:119], v[164:167], v[128:143]
    v_mfma_f32_32x32x16_bf16 v[64:79], a[28:31], v[168:171], v[80:95]
    s_nop 11
    v_exp_f32 v64, v64
    v_exp_f32 v65, v65
    v_exp_f32 v66, v66
    v_exp_f32 v67, v67
    v_exp_f32 v68, v68
    v_exp_f32 v69, v69
    v_exp_f32 v70, v70
    v_exp_f32 v71, v71
    v_exp_f32 v72, v72
    v_exp_f32 v73, v73
    v_exp_f32 v74, v74
    v_exp_f32 v75, v75
    v_exp_f32 v76, v76
    v_exp_f32 v77, v77
    v_exp_f32 v78, v78
    v_exp_f32 v79, v79
    v_cvt_pk_bf16_f32 v160, v64, v65
    v_cvt_pk_bf16_f32 v161, v66, v67
    v_cvt_pk_bf16_f32 v162, v68, v69
    v_cvt_pk_bf16_f32 v163, v70, v71
    v_cvt_pk_bf16_f32 v164, v72, v73
    v_cvt_pk_bf16_f32 v165, v74, v75
    v_cvt_pk_bf16_f32 v166, v76, v77
    v_cvt_pk_bf16_f32 v167, v78, v79
    v_mfma_f32_32x32x16_bf16 v[128:143], a[120:123], v[160:163], v[128:143]
    s_nop 0
    v_mfma_f32_32x32x16_bf16 v[128:143], a[124:127], v[164:167], v[128:143]
    v_mfma_f32_32x32x16_bf16 v[64:79], a[32:35], v[168:171], v[80:95]
    s_nop 11
    v_exp_f32 v64, v64
    v_exp_f32 v65, v65
    v_exp_f32 v66, v66
    v_exp_f32 v67, v67
    v_exp_f32 v68, v68
    v_exp_f32 v69, v69
    v_exp_f32 v70, v70
    v_exp_f32 v71, v71
    v_exp_f32 v72, v72
    v_exp_f32 v73, v73
    v_exp_f32 v74, v74
    v_exp_f32 v75, v75
    v_exp_f32 v76, v76
    v_exp_f32 v77, v77
    v_exp_f32 v78, v78
    v_exp_f32 v79, v79
    v_cvt_pk_bf16_f32 v160, v64, v65
    v_cvt_pk_bf16_f32 v161, v66, v67
    v_cvt_pk_bf16_f32 v162, v68, v69
    v_cvt_pk_bf16_f32 v163, v70, v71
    v_cvt_pk_bf16_f32 v164, v72, v73
    v_cvt_pk_bf16_f32 v165, v74, v75
    v_cvt_pk_bf16_f32 v166, v76, v77
    v_cvt_pk_bf16_f32 v167, v78, v79
    v_mfma_f32_32x32x16_bf16 v[128:143], a[128:131], v[160:163], v[128:143]
    s_nop 0
    v_mfma_f32_32x32x16_bf16 v[128:143], a[132:135], v[164:167], v[128:143]
    v_mfma_f32_32x32x16_bf16 v[64:79], a[36:39], v[168:171], v[80:95]
    s_nop 11
    v_exp_f32 v64, v64
    v_exp_f32 v65, v65
    v_exp_f32 v66, v66
    v_exp_f32 v67, v67
    v_exp_f32 v68, v68
    v_exp_f32 v69, v69
    v_exp_f32 v70, v70
    v_exp_f32 v71, v71
    v_exp_f32 v72, v72
    v_exp_f32 v73, v73
    v_exp_f32 v74, v74
    v_exp_f32 v75, v75
    v_exp_f32 v76, v76
    v_exp_f32 v77, v77
    v_exp_f32 v78, v78
    v_exp_f32 v79, v79
    v_cvt_pk_bf16_f32 v160, v64, v65
    v_cvt_pk_bf16_f32 v161, v66, v67
    v_cvt_pk_bf16_f32 v162, v68, v69
    v_cvt_pk_bf16_f32 v163, v70, v71
    v_cvt_pk_bf16_f32 v164, v72, v73
    v_cvt_pk_bf16_f32 v165, v74, v75
    v_cvt_pk_bf16_f32 v166, v76, v77
    v_cvt_pk_bf16_f32 v167, v78, v79
    v_mfma_f32_32x32x16_bf16 v[128:143], a[136:139], v[160:163], v[128:143]
    s_nop 0
    v_mfma_f32_32x32x16_bf16 v[128:143], a[140:143], v[164:167], v[128:143]
    v_mfma_f32_32x32x16_bf16 v[64:79], a[40:43], v[168:171], v[80:95]
    s_nop 11
    v_exp_f32 v64, v64
    v_exp_f32 v65, v65
    v_exp_f32 v66, v66
    v_exp_f32 v67, v67
    v_exp_f32 v68, v68
    v_exp_f32 v69, v69
    v_exp_f32 v70, v70
    v_exp_f32 v71, v71
    v_exp_f32 v72, v72
    v_exp_f32 v73, v73
    v_exp_f32 v74, v74
    v_exp_f32 v75, v75
    v_exp_f32 v76, v76
    v_exp_f32 v77, v77
    v_exp_f32 v78, v78
    v_exp_f32 v79, v79
    v_cvt_pk_bf16_f32 v160, v64, v65
    v_cvt_pk_bf16_f32 v161, v66, v67
    v_cvt_pk_bf16_f32 v162, v68, v69
    v_cvt_pk_bf16_f32 v163, v70, v71
    v_cvt_pk_bf16_f32 v164, v72, v73
    v_cvt_pk_bf16_f32 v165, v74, v75
    v_cvt_pk_bf16_f32 v166, v76, v77
    v_cvt_pk_bf16_f32 v167, v78, v79
    v_mfma_f32_32x32x16_bf16 v[128:143], a[144:147], v[160:163], v[128:143]
    s_nop 0
    v_mfma_f32_32x32x16_bf16 v[128:143], a[148:151], v[164:167], v[128:143]
    v_mfma_f32_32x32x16_bf16 v[64:79], a[44:47], v[168:171], v[80:95]
    s_nop 11
    v_exp_f32 v64, v64
    v_exp_f32 v65, v65
    v_exp_f32 v66, v66
    v_exp_f32 v67, v67
    v_exp_f32 v68, v68
    v_exp_f32 v69, v69
    v_exp_f32 v70, v70
    v_exp_f32 v71, v71
    v_exp_f32 v72, v72
    v_exp_f32 v73, v73
    v_exp_f32 v74, v74
    v_exp_f32 v75, v75
    v_exp_f32 v76, v76
    v_exp_f32 v77, v77
    v_exp_f32 v78, v78
    v_exp_f32 v79, v79
    v_cvt_pk_bf16_f32 v160, v64, v65
    v_cvt_pk_bf16_f32 v161, v66, v67
    v_cvt_pk_bf16_f32 v162, v68, v69
    v_cvt_pk_bf16_f32 v163, v70, v71
    v_cvt_pk_bf16_f32 v164, v72, v73
    v_cvt_pk_bf16_f32 v165, v74, v75
    v_cvt_pk_bf16_f32 v166, v76, v77
    v_cvt_pk_bf16_f32 v167, v78, v79
    v_mfma_f32_32x32x16_bf16 v[128:143], a[152:155], v[160:163], v[128:143]
    s_nop 0
    v_mfma_f32_32x32x16_bf16 v[128:143], a[156:159], v[164:167], v[128:143]
    v_mfma_f32_32x32x16_bf16 v[64:79], a[48:51], v[168:171], v[80:95]
    s_nop 11
    v_exp_f32 v64, v64
    v_exp_f32 v65, v65
    v_exp_f32 v66, v66
    v_exp_f32 v67, v67
    v_exp_f32 v68, v68
    v_exp_f32 v69, v69
    v_exp_f32 v70, v70
    v_exp_f32 v71, v71
    v_exp_f32 v72, v72
    v_exp_f32 v73, v73
    v_exp_f32 v74, v74
    v_exp_f32 v75, v75
    v_exp_f32 v76, v76
    v_exp_f32 v77, v77
    v_exp_f32 v78, v78
    v_exp_f32 v79, v79
    v_cvt_pk_bf16_f32 v160, v64, v65
    v_cvt_pk_bf16_f32 v161, v66, v67
    v_cvt_pk_bf16_f32 v162, v68, v69
    v_cvt_pk_bf16_f32 v163, v70, v71
    v_cvt_pk_bf16_f32 v164, v72, v73
    v_cvt_pk_bf16_f32 v165, v74, v75
    v_cvt_pk_bf16_f32 v166, v76, v77
    v_cvt_pk_bf16_f32 v167, v78, v79
    v_mfma_f32_32x32x16_bf16 v[128:143], a[160:163], v[160:163], v[128:143]
    s_nop 0
    v_mfma_f32_32x32x16_bf16 v[128:143], a[164:167], v[164:167], v[128:143]
    v_mfma_f32_32x32x16_bf16 v[64:79], a[52:55], v[168:171], v[80:95]
    s_nop 11
    v_exp_f32 v64, v64
    v_exp_f32 v65, v65
    v_exp_f32 v66, v66
    v_exp_f32 v67, v67
    v_exp_f32 v68, v68
    v_exp_f32 v69, v69
    v_exp_f32 v70, v70
    v_exp_f32 v71, v71
    v_exp_f32 v72, v72
    v_exp_f32 v73, v73
    v_exp_f32 v74, v74
    v_exp_f32 v75, v75
    v_exp_f32 v76, v76
    v_exp_f32 v77, v77
    v_exp_f32 v78, v78
    v_exp_f32 v79, v79
    v_cvt_pk_bf16_f32 v160, v64, v65
    v_cvt_pk_bf16_f32 v161, v66, v67
    v_cvt_pk_bf16_f32 v162, v68, v69
    v_cvt_pk_bf16_f32 v163, v70, v71
    v_cvt_pk_bf16_f32 v164, v72, v73
    v_cvt_pk_bf16_f32 v165, v74, v75
    v_cvt_pk_bf16_f32 v166, v76, v77
    v_cvt_pk_bf16_f32 v167, v78, v79
    v_mfma_f32_32x32x16_bf16 v[128:143], a[168:171], v[160:163], v[128:143]
    s_nop 0
    v_mfma_f32_32x32x16_bf16 v[128:143], a[172:175], v[164:167], v[128:143]
    v_mfma_f32_32x32x16_bf16 v[64:79], a[56:59], v[168:171], v[80:95]
    s_nop 11
    v_exp_f32 v64, v64
    v_exp_f32 v65, v65
    v_exp_f32 v66, v66
    v_exp_f32 v67, v67
    v_exp_f32 v68, v68
    v_exp_f32 v69, v69
    v_exp_f32 v70, v70
    v_exp_f32 v71, v71
    v_exp_f32 v72, v72
    v_exp_f32 v73, v73
    v_exp_f32 v74, v74
    v_exp_f32 v75, v75
    v_exp_f32 v76, v76
    v_exp_f32 v77, v77
    v_exp_f32 v78, v78
    v_exp_f32 v79, v79
    v_cvt_pk_bf16_f32 v160, v64, v65
    v_cvt_pk_bf16_f32 v161, v66, v67
    v_cvt_pk_bf16_f32 v162, v68, v69
    v_cvt_pk_bf16_f32 v163, v70, v71
    v_cvt_pk_bf16_f32 v164, v72, v73
    v_cvt_pk_bf16_f32 v165, v74, v75
    v_cvt_pk_bf16_f32 v166, v76, v77
    v_cvt_pk_bf16_f32 v167, v78, v79
    v_mfma_f32_32x32x16_bf16 v[128:143], a[176:179], v[160:163], v[128:143]
    s_nop 0
    v_mfma_f32_32x32x16_bf16 v[128:143], a[180:183], v[164:167], v[128:143]
    v_mfma_f32_32x32x16_bf16 v[64:79], a[60:63], v[168:171], v[80:95]
    s_nop 11
    v_exp_f32 v64, v64
    v_exp_f32 v65, v65
    v_exp_f32 v66, v66
    v_exp_f32 v67, v67
    v_exp_f32 v68, v68
    v_exp_f32 v69, v69
    v_exp_f32 v70, v70
    v_exp_f32 v71, v71
    v_exp_f32 v72, v72
    v_exp_f32 v73, v73
    v_exp_f32 v74, v74
    v_exp_f32 v75, v75
    v_exp_f32 v76, v76
    v_exp_f32 v77, v77
    v_exp_f32 v78, v78
    v_exp_f32 v79, v79
    v_cvt_pk_bf16_f32 v160, v64, v65
    v_cvt_pk_bf16_f32 v161, v66, v67
    v_cvt_pk_bf16_f32 v162, v68, v69
    v_cvt_pk_bf16_f32 v163, v70, v71
    v_cvt_pk_bf16_f32 v164, v72, v73
    v_cvt_pk_bf16_f32 v165, v74, v75
    v_cvt_pk_bf16_f32 v166, v76, v77
    v_cvt_pk_bf16_f32 v167, v78, v79
    v_mfma_f32_32x32x16_bf16 v[128:143], a[184:187], v[160:163], v[128:143]
    s_nop 0
    v_mfma_f32_32x32x16_bf16 v[128:143], a[188:191], v[164:167], v[128:143]
    s_nop 7
    s_nop 7
    ds_write_b128 v8, v[128:131]
    ds_write_b128 v8, v[132:135] offset:1024
    ds_write_b32 v9, v136 offset:2048
    v_add_u32 v8, 9216, v8
    v_add_u32 v9, 9216, v9
    v_add_u32 v10, 1024, v10
    s_add_u32 s36, s36, 1024
    s_sub_u32 s35, s35, 1
    s_cmp_lg_u32 s35, 0
    s_cbranch_scc1 mg_SL2
    s_mov_b32 s47, 1
    s_branch mg_RED
    s_endpgm
.section .rodata,"a"
.p2align 6
.amdhsa_kernel interleave_layers__softmax_full_mha__glu_gated_glu__prompt_kernel
  .amdhsa_next_free_vgpr 512
  .amdhsa_next_free_sgpr 102
  .amdhsa_accum_offset 256
  .amdhsa_group_segment_fixed_size 0
  .amdhsa_kernarg_size 80
  .amdhsa_user_sgpr_count 2
  .amdhsa_user_sgpr_kernarg_segment_ptr 1
  .amdhsa_system_sgpr_workgroup_id_x 1
  .amdhsa_float_denorm_mode_32 3
  .amdhsa_float_denorm_mode_16_64 3
.end_amdhsa_kernel
.text
```
